```python
import torch

def _softmax(x, axis=-1):
    return torch.softmax(x, dim=axis)
def _gelu(x):
    return torch.nn.functional.gelu(x, approximate="tanh")
def _silu(x):
    return torch.nn.functional.silu(x)
def _sigmoid(x):
    return torch.sigmoid(x)
def _layernorm(x, axis=-1, eps=1e-5):
    m = x.mean(dim=axis, keepdim=True)
    v = x.var(dim=axis, keepdim=True, unbiased=False)
    return (x - m) / torch.sqrt(v + eps)
def _scatter_add(tgt, idx, src, axis=0):
    return tgt.clone().index_add_(axis, idx, src)
def _segment_sum(src, seg, n):
    out = torch.zeros((n,) + src.shape[1:], dtype=src.dtype)
    return out.index_add_(0, seg, src)
def _pad(x, pw):
    flat = tuple(v for pair in reversed(pw) for v in pair)
    return torch.nn.functional.pad(x, flat)

kernel_name = 'gated_mix__gqa_block_cached__glu_gated_reglu__decode'

def setup_inputs():

    _w = (lambda a: (lambda t: t.to(torch.bfloat16) if t.is_floating_point() else t)(torch.as_tensor(a)))
    def _A_setup():
        B, Sq, D = 1, 1, 448
        Hq, Hkv, Sk, Dh = 16, 8, 65536, 256
        assert Hq % Hkv == 0, (Hq, Hkv)
        return {
            "x": _w((lambda *s: torch.randn(*s, dtype=torch.bfloat16) * 0.05)(B, Sq, D)),
            "k_cache": _w((lambda *s: torch.randn(*s, dtype=torch.bfloat16) * 6.4)(B, Hkv, Sk, Dh)),
            "v_cache": _w((lambda *s: torch.randn(*s, dtype=torch.bfloat16) * 0.05)(B, Hkv, Sk, Dh)),
            "wq": _w((lambda *s: torch.randn(*s, dtype=torch.bfloat16) * 6.4)(D, Hq * Dh) * (D ** -0.5)),
            "wo": _w((lambda *s: torch.randn(*s, dtype=torch.bfloat16) * 0.05)(Hq * Dh, D) * ((Hq * Dh) ** -0.5)),
        }
    _A_in = _A_setup()

    def _B_setup():
        B, S, D, F = 1, 1, 448, 1792
        return {
            "x": _w((lambda *s: torch.randn(*s, dtype=torch.bfloat16) * 0.05)(B, S, D)),
            "W_gate": _w((lambda *s: torch.randn(*s, dtype=torch.bfloat16) * 0.4)(D, F) * (2.0 / D) ** 0.5),
            "W_up": _w((lambda *s: torch.randn(*s, dtype=torch.bfloat16) * 0.4)(D, F) * (2.0 / D) ** 0.5),
            "W_down": _w((lambda *s: torch.randn(*s, dtype=torch.bfloat16) * 0.4)(F, D) * (1.0 / F) ** 0.5),
        }
    _B_in = _B_setup()

    return {
        "A_x": _A_in["x"],
        "A_k_cache": _A_in["k_cache"],
        "A_v_cache": _A_in["v_cache"],
        "A_wq": _A_in["wq"],
        "A_wo": _A_in["wo"],
        "B_x": _B_in["x"],
        "B_W_gate": _B_in["W_gate"],
        "B_W_up": _B_in["W_up"],
        "B_W_down": _B_in["W_down"],
        "gate_w": _w((lambda *s: torch.randn(*s, dtype=torch.bfloat16) * 0.05)(448) * 16.0),
    }

def reference(A_x, A_k_cache, A_v_cache, A_wq, A_wo, B_x, B_W_gate, B_W_up, B_W_down, gate_w):
    def _A_ref(x, k_cache, v_cache, wq, wo):
        B, Sq, D = x.shape
        Hq, Dh = 16, 256
        Hkv = k_cache.shape[1]
        rep = Hq // Hkv
        q = (lambda x, *d: x.permute(*d))((x @ wq).reshape(B, Sq, Hq, Dh), 0, 2, 1, 3)
        k = (lambda x, n, axis: torch.repeat_interleave(x, n, dim=axis))(k_cache, rep, axis=1)
        v = (lambda x, n, axis: torch.repeat_interleave(x, n, dim=axis))(v_cache, rep, axis=1)
        scores = torch.einsum("bhqd,bhkd->bhqk", q, k) * (Dh ** -0.5)
        p = _softmax(scores, axis=-1)
        o = torch.einsum("bhqk,bhkd->bhqd", p, v)
        return (lambda x, *d: x.permute(*d))(o, 0, 2, 1, 3).reshape(B, Sq, Hq * Dh) @ wo

    def _B_ref(x, W_gate, W_up, W_down):
        gate = torch.einsum("bsd,df->bsf", x, W_gate)
        up = torch.einsum("bsd,df->bsf", x, W_up)
        gate = gate * (lambda x, dt: x.to(dt))(gate > 0, gate.dtype)
        h = gate * up
        return torch.einsum("bsf,fd->bsd", h, W_down)

    x = A_x
    g = _sigmoid((x * gate_w).sum(-1, keepdims=True))
    a = _A_ref(x, A_k_cache, A_v_cache, A_wq, A_wo)
    b = _B_ref(x, B_W_gate, B_W_up, B_W_down)
    return g * a + (1 - g) * b
```

```asm
; @launch grid=(256,1,1) block=(512,1,1) lds=22528
.amdgcn_target "amdgcn-amd-amdhsa--gfx950"
.text
.globl gated_mix__gqa_block_cached__glu_gated_reglu__decode_kernel
.p2align 8
.type gated_mix__gqa_block_cached__glu_gated_reglu__decode_kernel,@function
gated_mix__gqa_block_cached__glu_gated_reglu__decode_kernel:
KSTART:
  s_cmp_ge_u32 s2, 256
  s_cbranch_scc1 L_end
  s_load_dwordx16 s[4:19], s[0:1], 0
  s_load_dwordx8 s[20:27], s[0:1], 64
  s_load_dwordx2 s[28:29], s[0:1], 96
  v_lshrrev_b32 v1, 6, v0
  v_and_b32 v0, 63, v0
  v_readfirstlane_b32 s3, v1
  s_lshr_b32 s30, s2, 5
  s_and_b32 s31, s2, 31
  s_mov_b32 s93, s3
  s_waitcnt lgkmcnt(0)
  s_mov_b32 s40, s28
  s_mov_b32 s41, s29
  s_mov_b32 s42, 0x40000000
  s_mov_b32 s43, 0x00020000
  s_cmp_lg_u32 s3, 0
  s_cbranch_scc1 L_stream
L_helper:
  s_setprio 3
  s_mov_b32 s44, s4
  s_mov_b32 s45, s5
  s_mov_b32 s46, 896
  s_mov_b32 s47, 0x00020000
  s_mov_b32 s48, s10
  s_mov_b32 s49, s11
  s_mov_b32 s50, 3670016
  s_mov_b32 s51, 0x00020000
  v_lshlrev_b32 v1, 4, v0
  v_and_b32 v2, 1, v0
  v_lshrrev_b32 v3, 1, v0
  v_mov_b32 v4, 0
  s_cmp_lg_u32 s31, 0
  s_cbranch_scc1 L_nozero
  s_lshl_b32 s57, s30, 12
  s_add_u32 s57, s57, 3670016
  s_mov_b64 exec, 1
  buffer_store_dword v4, v4, s[40:43], s57 offen sc1
  s_mov_b64 exec, -1
L_nozero:
  buffer_load_dword v5, v4, s[40:43], 0 offen sc1
  v_lshlrev_b32 v6, 1, v3
  buffer_load_ushort v32, v6, s[44:47], 0 offen offset:0 nt
  buffer_load_ushort v33, v6, s[44:47], 0 offen offset:64 nt
  buffer_load_ushort v34, v6, s[44:47], 0 offen offset:128 nt
  buffer_load_ushort v35, v6, s[44:47], 0 offen offset:192 nt
  buffer_load_ushort v36, v6, s[44:47], 0 offen offset:256 nt
  buffer_load_ushort v37, v6, s[44:47], 0 offen offset:320 nt
  buffer_load_ushort v38, v6, s[44:47], 0 offen offset:384 nt
  buffer_load_ushort v39, v6, s[44:47], 0 offen offset:448 nt
  buffer_load_ushort v40, v6, s[44:47], 0 offen offset:512 nt
  buffer_load_ushort v41, v6, s[44:47], 0 offen offset:576 nt
  buffer_load_ushort v42, v6, s[44:47], 0 offen offset:640 nt
  buffer_load_ushort v43, v6, s[44:47], 0 offen offset:704 nt
  buffer_load_ushort v44, v6, s[44:47], 0 offen offset:768 nt
  buffer_load_ushort v45, v6, s[44:47], 0 offen offset:832 nt
  s_and_b32 s56, s31, 7
  s_lshl_b32 s56, s56, 2
  s_lshr_b32 s57, s31, 3
  s_add_u32 s56, s56, s57
  s_lshl_b32 s57, s30, 10
  s_lshl_b32 s58, s56, 5
  s_add_u32 s57, s57, s58
  v_lshlrev_b32 v7, 13, v3
  v_lshl_add_u32 v7, v2, 4, v7
  v_add_u32 v7, s57, v7
  s_mov_b32 s63, 0
  buffer_load_dwordx4 v[64:67], v7, s[48:51], s63 offen nt
  s_mov_b32 s63, 262144
  buffer_load_dwordx4 v[68:71], v7, s[48:51], s63 offen nt
  s_mov_b32 s63, 524288
  buffer_load_dwordx4 v[72:75], v7, s[48:51], s63 offen nt
  s_mov_b32 s63, 786432
  buffer_load_dwordx4 v[76:79], v7, s[48:51], s63 offen nt
  s_mov_b32 s63, 1048576
  buffer_load_dwordx4 v[80:83], v7, s[48:51], s63 offen nt
  s_mov_b32 s63, 1310720
  buffer_load_dwordx4 v[84:87], v7, s[48:51], s63 offen nt
  s_mov_b32 s63, 1572864
  buffer_load_dwordx4 v[88:91], v7, s[48:51], s63 offen nt
  s_mov_b32 s63, 1835008
  buffer_load_dwordx4 v[92:95], v7, s[48:51], s63 offen nt
  s_mov_b32 s63, 2097152
  buffer_load_dwordx4 v[96:99], v7, s[48:51], s63 offen nt
  s_mov_b32 s63, 2359296
  buffer_load_dwordx4 v[100:103], v7, s[48:51], s63 offen nt
  s_mov_b32 s63, 2621440
  buffer_load_dwordx4 v[104:107], v7, s[48:51], s63 offen nt
  s_mov_b32 s63, 2883584
  buffer_load_dwordx4 v[108:111], v7, s[48:51], s63 offen nt
  s_mov_b32 s63, 3145728
  buffer_load_dwordx4 v[112:115], v7, s[48:51], s63 offen nt
  s_mov_b32 s63, 3407872
  buffer_load_dwordx4 v[116:119], v7, s[48:51], s63 offen nt
  s_mov_b32 s53, 0x05040100
  s_mov_b32 s54, 0x07060302
  s_mov_b32 s55, 0xffff0000
  s_mov_b32 s52, 0x3db8aa3b
  s_lshl_b32 s71, s30, 5
  s_add_u32 s71, s71, s31
  s_lshl_b32 s59, s30, 11
  s_add_u32 s59, s59, 4096
  s_lshl_b32 s58, s56, 6
  s_add_u32 s58, s58, s59
  v_mov_b32 v9, 0
  v_mov_b32 v10, 0
  v_mov_b32 v11, 0
  ds_write_b64 v4, v[10:11] offset:1032
  s_mov_b32 s94, 0
  s_mov_b64 s[96:97], -1
  s_barrier
L_qpass:
  s_cmp_lg_u32 s94, 0
  s_cbranch_scc1 L_dskip_1
  s_waitcnt vmcnt(14)
  s_mov_b32 s63, 1664525
  v_mul_lo_u32 v5, v5, s63
  v_add_u32 v5, 1013904223, v5
  s_nop 1
  v_readfirstlane_b32 s62, v5
  v_lshl_or_b32 v32, v33, 16, v32
  v_lshl_or_b32 v33, v35, 16, v34
  v_lshl_or_b32 v34, v37, 16, v36
  v_lshl_or_b32 v35, v39, 16, v38
  v_lshl_or_b32 v36, v41, 16, v40
  v_lshl_or_b32 v37, v43, 16, v42
  v_lshl_or_b32 v38, v45, 16, v44
L_dskip_1:
  v_mov_b32 v16, 0
  v_mov_b32 v17, 0
  v_mov_b32 v18, 0
  v_mov_b32 v19, 0
  v_mov_b32 v20, 0
  v_mov_b32 v21, 0
  v_mov_b32 v22, 0
  v_mov_b32 v23, 0
  s_cmp_lg_u32 s94, 0
  s_cbranch_scc1 L_dskip_2
  s_waitcnt vmcnt(12)
L_dskip_2:
  v_perm_b32 v24, v68, v64, s53
  v_perm_b32 v25, v68, v64, s54
  v_dot2_f32_bf16 v16, v24, v32, v16
  v_dot2_f32_bf16 v17, v25, v32, v17
  v_perm_b32 v26, v69, v65, s53
  v_perm_b32 v27, v69, v65, s54
  v_dot2_f32_bf16 v18, v26, v32, v18
  v_dot2_f32_bf16 v19, v27, v32, v19
  v_perm_b32 v24, v70, v66, s53
  v_perm_b32 v25, v70, v66, s54
  v_dot2_f32_bf16 v20, v24, v32, v20
  v_dot2_f32_bf16 v21, v25, v32, v21
  v_perm_b32 v26, v71, v67, s53
  v_perm_b32 v27, v71, v67, s54
  v_dot2_f32_bf16 v22, v26, v32, v22
  v_dot2_f32_bf16 v23, v27, v32, v23
  s_cmp_lg_u32 s94, 0
  s_cbranch_scc1 L_dskip_3
  s_waitcnt vmcnt(10)
L_dskip_3:
  v_perm_b32 v24, v76, v72, s53
  v_perm_b32 v25, v76, v72, s54
  v_dot2_f32_bf16 v16, v24, v33, v16
  v_dot2_f32_bf16 v17, v25, v33, v17
  v_perm_b32 v26, v77, v73, s53
  v_perm_b32 v27, v77, v73, s54
  v_dot2_f32_bf16 v18, v26, v33, v18
  v_dot2_f32_bf16 v19, v27, v33, v19
  v_perm_b32 v24, v78, v74, s53
  v_perm_b32 v25, v78, v74, s54
  v_dot2_f32_bf16 v20, v24, v33, v20
  v_dot2_f32_bf16 v21, v25, v33, v21
  v_perm_b32 v26, v79, v75, s53
  v_perm_b32 v27, v79, v75, s54
  v_dot2_f32_bf16 v22, v26, v33, v22
  v_dot2_f32_bf16 v23, v27, v33, v23
  s_cmp_lg_u32 s94, 0
  s_cbranch_scc1 L_dskip_4
  s_waitcnt vmcnt(8)
L_dskip_4:
  v_perm_b32 v24, v84, v80, s53
  v_perm_b32 v25, v84, v80, s54
  v_dot2_f32_bf16 v16, v24, v34, v16
  v_dot2_f32_bf16 v17, v25, v34, v17
  v_perm_b32 v26, v85, v81, s53
  v_perm_b32 v27, v85, v81, s54
  v_dot2_f32_bf16 v18, v26, v34, v18
  v_dot2_f32_bf16 v19, v27, v34, v19
  v_perm_b32 v24, v86, v82, s53
  v_perm_b32 v25, v86, v82, s54
  v_dot2_f32_bf16 v20, v24, v34, v20
  v_dot2_f32_bf16 v21, v25, v34, v21
  v_perm_b32 v26, v87, v83, s53
  v_perm_b32 v27, v87, v83, s54
  v_dot2_f32_bf16 v22, v26, v34, v22
  v_dot2_f32_bf16 v23, v27, v34, v23
  s_cmp_lg_u32 s94, 0
  s_cbranch_scc1 L_dskip_5
  s_waitcnt vmcnt(6)
L_dskip_5:
  v_perm_b32 v24, v92, v88, s53
  v_perm_b32 v25, v92, v88, s54
  v_dot2_f32_bf16 v16, v24, v35, v16
  v_dot2_f32_bf16 v17, v25, v35, v17
  v_perm_b32 v26, v93, v89, s53
  v_perm_b32 v27, v93, v89, s54
  v_dot2_f32_bf16 v18, v26, v35, v18
  v_dot2_f32_bf16 v19, v27, v35, v19
  v_perm_b32 v24, v94, v90, s53
  v_perm_b32 v25, v94, v90, s54
  v_dot2_f32_bf16 v20, v24, v35, v20
  v_dot2_f32_bf16 v21, v25, v35, v21
  v_perm_b32 v26, v95, v91, s53
  v_perm_b32 v27, v95, v91, s54
  v_dot2_f32_bf16 v22, v26, v35, v22
  v_dot2_f32_bf16 v23, v27, v35, v23
  s_cmp_lg_u32 s94, 0
  s_cbranch_scc1 L_dskip_6
  s_waitcnt vmcnt(4)
L_dskip_6:
  v_perm_b32 v24, v100, v96, s53
  v_perm_b32 v25, v100, v96, s54
  v_dot2_f32_bf16 v16, v24, v36, v16
  v_dot2_f32_bf16 v17, v25, v36, v17
  v_perm_b32 v26, v101, v97, s53
  v_perm_b32 v27, v101, v97, s54
  v_dot2_f32_bf16 v18, v26, v36, v18
  v_dot2_f32_bf16 v19, v27, v36, v19
  v_perm_b32 v24, v102, v98, s53
  v_perm_b32 v25, v102, v98, s54
  v_dot2_f32_bf16 v20, v24, v36, v20
  v_dot2_f32_bf16 v21, v25, v36, v21
  v_perm_b32 v26, v103, v99, s53
  v_perm_b32 v27, v103, v99, s54
  v_dot2_f32_bf16 v22, v26, v36, v22
  v_dot2_f32_bf16 v23, v27, v36, v23
  s_cmp_lg_u32 s94, 0
  s_cbranch_scc1 L_dskip_7
  s_waitcnt vmcnt(2)
L_dskip_7:
  v_perm_b32 v24, v108, v104, s53
  v_perm_b32 v25, v108, v104, s54
  v_dot2_f32_bf16 v16, v24, v37, v16
  v_dot2_f32_bf16 v17, v25, v37, v17
  v_perm_b32 v26, v109, v105, s53
  v_perm_b32 v27, v109, v105, s54
  v_dot2_f32_bf16 v18, v26, v37, v18
  v_dot2_f32_bf16 v19, v27, v37, v19
  v_perm_b32 v24, v110, v106, s53
  v_perm_b32 v25, v110, v106, s54
  v_dot2_f32_bf16 v20, v24, v37, v20
  v_dot2_f32_bf16 v21, v25, v37, v21
  v_perm_b32 v26, v111, v107, s53
  v_perm_b32 v27, v111, v107, s54
  v_dot2_f32_bf16 v22, v26, v37, v22
  v_dot2_f32_bf16 v23, v27, v37, v23
  s_cmp_lg_u32 s94, 0
  s_cbranch_scc1 L_dskip_8
  s_waitcnt vmcnt(0)
L_dskip_8:
  v_perm_b32 v24, v116, v112, s53
  v_perm_b32 v25, v116, v112, s54
  v_dot2_f32_bf16 v16, v24, v38, v16
  v_dot2_f32_bf16 v17, v25, v38, v17
  v_perm_b32 v26, v117, v113, s53
  v_perm_b32 v27, v117, v113, s54
  v_dot2_f32_bf16 v18, v26, v38, v18
  v_dot2_f32_bf16 v19, v27, v38, v19
  v_perm_b32 v24, v118, v114, s53
  v_perm_b32 v25, v118, v114, s54
  v_dot2_f32_bf16 v20, v24, v38, v20
  v_dot2_f32_bf16 v21, v25, v38, v21
  v_perm_b32 v26, v119, v115, s53
  v_perm_b32 v27, v119, v115, s54
  v_dot2_f32_bf16 v22, v26, v38, v22
  v_dot2_f32_bf16 v23, v27, v38, v23
  s_nop 2
  v_add_f32_dpp v16, v16, v16 row_ror:2 row_mask:0xf bank_mask:0xf
  v_add_f32_dpp v17, v17, v17 row_ror:2 row_mask:0xf bank_mask:0xf
  v_add_f32_dpp v18, v18, v18 row_ror:2 row_mask:0xf bank_mask:0xf
  v_add_f32_dpp v19, v19, v19 row_ror:2 row_mask:0xf bank_mask:0xf
  v_add_f32_dpp v20, v20, v20 row_ror:2 row_mask:0xf bank_mask:0xf
  v_add_f32_dpp v21, v21, v21 row_ror:2 row_mask:0xf bank_mask:0xf
  v_add_f32_dpp v22, v22, v22 row_ror:2 row_mask:0xf bank_mask:0xf
  v_add_f32_dpp v23, v23, v23 row_ror:2 row_mask:0xf bank_mask:0xf
  v_add_f32_dpp v16, v16, v16 row_ror:4 row_mask:0xf bank_mask:0xf
  v_add_f32_dpp v17, v17, v17 row_ror:4 row_mask:0xf bank_mask:0xf
  v_add_f32_dpp v18, v18, v18 row_ror:4 row_mask:0xf bank_mask:0xf
  v_add_f32_dpp v19, v19, v19 row_ror:4 row_mask:0xf bank_mask:0xf
  v_add_f32_dpp v20, v20, v20 row_ror:4 row_mask:0xf bank_mask:0xf
  v_add_f32_dpp v21, v21, v21 row_ror:4 row_mask:0xf bank_mask:0xf
  v_add_f32_dpp v22, v22, v22 row_ror:4 row_mask:0xf bank_mask:0xf
  v_add_f32_dpp v23, v23, v23 row_ror:4 row_mask:0xf bank_mask:0xf
  v_add_f32_dpp v16, v16, v16 row_ror:8 row_mask:0xf bank_mask:0xf
  v_add_f32_dpp v17, v17, v17 row_ror:8 row_mask:0xf bank_mask:0xf
  v_add_f32_dpp v18, v18, v18 row_ror:8 row_mask:0xf bank_mask:0xf
  v_add_f32_dpp v19, v19, v19 row_ror:8 row_mask:0xf bank_mask:0xf
  v_add_f32_dpp v20, v20, v20 row_ror:8 row_mask:0xf bank_mask:0xf
  v_add_f32_dpp v21, v21, v21 row_ror:8 row_mask:0xf bank_mask:0xf
  v_add_f32_dpp v22, v22, v22 row_ror:8 row_mask:0xf bank_mask:0xf
  v_add_f32_dpp v23, v23, v23 row_ror:8 row_mask:0xf bank_mask:0xf
  v_mov_b32 v48, v16
  v_mov_b32 v49, v17
  v_mov_b32 v50, v18
  v_mov_b32 v51, v19
  v_mov_b32 v52, v20
  v_mov_b32 v53, v21
  v_mov_b32 v54, v22
  v_mov_b32 v55, v23
  s_nop 1
  v_permlane16_swap_b32 v16, v48
  v_permlane16_swap_b32 v17, v49
  v_permlane16_swap_b32 v18, v50
  v_permlane16_swap_b32 v19, v51
  v_permlane16_swap_b32 v20, v52
  v_permlane16_swap_b32 v21, v53
  v_permlane16_swap_b32 v22, v54
  v_permlane16_swap_b32 v23, v55
  s_nop 1
  v_add_f32 v16, v16, v48
  v_add_f32 v17, v17, v49
  v_add_f32 v18, v18, v50
  v_add_f32 v19, v19, v51
  v_add_f32 v20, v20, v52
  v_add_f32 v21, v21, v53
  v_add_f32 v22, v22, v54
  v_add_f32 v23, v23, v55
  v_mov_b32 v48, v16
  v_mov_b32 v49, v17
  v_mov_b32 v50, v18
  v_mov_b32 v51, v19
  v_mov_b32 v52, v20
  v_mov_b32 v53, v21
  v_mov_b32 v54, v22
  v_mov_b32 v55, v23
  s_nop 1
  v_permlane32_swap_b32 v16, v48
  v_permlane32_swap_b32 v17, v49
  v_permlane32_swap_b32 v18, v50
  v_permlane32_swap_b32 v19, v51
  v_permlane32_swap_b32 v20, v52
  v_permlane32_swap_b32 v21, v53
  v_permlane32_swap_b32 v22, v54
  v_permlane32_swap_b32 v23, v55
  s_nop 1
  v_add_f32 v16, v16, v48
  v_add_f32 v17, v17, v49
  v_add_f32 v18, v18, v50
  v_add_f32 v19, v19, v51
  v_add_f32 v20, v20, v52
  v_add_f32 v21, v21, v53
  v_add_f32 v22, v22, v54
  v_add_f32 v23, v23, v55
  v_cvt_pk_bf16_f32 v24, v16, v17
  v_cvt_pk_bf16_f32 v25, v18, v19
  v_cvt_pk_bf16_f32 v26, v20, v21
  v_cvt_pk_bf16_f32 v27, v22, v23
  v_cmp_gt_u32 vcc, 2, v0
  s_nop 1
  v_cndmask_b32 v48, v26, v24, vcc
  v_cndmask_b32 v50, v27, v25, vcc
  v_mov_b32 v49, s62
  v_mov_b32 v51, s62
  v_lshlrev_b32 v8, 5, v2
  v_lshrrev_b32 v9, 1, v0
  v_lshl_add_u32 v8, v9, 4, v8
  s_cmp_lg_u32 s94, 0
  s_cbranch_scc1 L_dskip_9
  s_mov_b64 exec, 15
  buffer_store_dwordx4 v[48:51], v8, s[40:43], s58 offen sc1
  s_mov_b64 exec, -1
L_dskip_9:
  v_lshlrev_b32 v8, 5, v0
  s_mov_b64 s[76:77], s[96:97]
  s_mov_b32 s70, 65536
L_poll_q:
  s_mov_b64 exec, s[76:77]
  s_cbranch_execz L_sk_q_0
  buffer_load_dwordx4 v[120:123], v8, s[40:43], s59 offen sc1
  buffer_load_dwordx4 v[124:127], v8, s[40:43], s59 offen offset:16 sc1
L_sk_q_0:
  s_mov_b64 exec, -1
  s_cmp_lg_u32 s94, 0
  s_cbranch_scc1 L_dskip_10
  s_waitcnt vmcnt(0)
L_dskip_10:
  s_mov_b64 s[66:67], 0
  v_max3_u32 v20, v121, v123, v125
  v_max_u32 v20, v20, v127
  v_min3_u32 v21, v121, v123, v125
  v_min_u32 v21, v21, v127
  v_xor_b32 v20, s62, v20
  v_xor_b32 v21, s62, v21
  v_or_b32 v20, v20, v21
  v_cmp_ne_u32 vcc, 0, v20
  s_and_b64 s[76:77], s[76:77], vcc
  s_mov_b64 s[66:67], s[76:77]
  s_cmp_eq_u64 s[66:67], 0
  s_cbranch_scc1 L_ok_q
  s_sub_u32 s70, s70, 1
  s_cmp_eq_u32 s70, 0
  s_cbranch_scc1 L_fail_q
  s_branch L_poll_q
L_fail_q:
  v_mov_b32 v28, 128
  v_mov_b32 v29, 1
  s_mov_b64 exec, 1
  global_atomic_add v28, v29, s[26:27]
  s_mov_b64 exec, -1
L_ok_q:
  v_mov_b32 v56, v120
  v_mov_b32 v57, v122
  v_mov_b32 v58, v124
  v_mov_b32 v59, v126
  v_mov_b32 v10, s62
  ds_write_b128 v1, v[56:59] offset:0
  ds_write_b32 v4, v10 offset:1024
  s_waitcnt lgkmcnt(0)
  s_barrier
  s_setprio 0
  s_cmp_ge_u32 s2, 112
  s_cbranch_scc1 L_noffn1
  s_lshr_b32 s56, s2, 1
  s_cmp_ge_u32 s56, 28
  s_cselect_b32 s57, 1, 0
  s_mul_i32 s58, s57, 28
  s_sub_u32 s58, s56, s58
  s_and_b32 s59, s2, 1
  s_cmp_eq_u32 s59, 0
  s_cselect_b32 s48, s16, s18
  s_cselect_b32 s49, s17, s19
  s_mov_b32 s50, 1605632
  s_mov_b32 s51, 0x00020000
  v_lshrrev_b32 v9, 3, v0
  v_and_b32 v10, 7, v0
  s_mul_i32 s60, s57, 448
  v_lshlrev_b32 v6, 1, v9
  v_add_u32 v6, s60, v6
  s_mov_b32 s63, 3584
  v_mul_lo_u32 v7, v9, s63
  v_lshl_add_u32 v7, v10, 4, v7
  s_lshl_b32 s61, s58, 7
  v_add_u32 v7, s61, v7
  s_mul_i32 s60, s57, 802816
  buffer_load_ushort v32, v6, s[44:47], 0 offen offset:0 nt
  buffer_load_ushort v33, v6, s[44:47], 0 offen offset:16 nt
  buffer_load_ushort v34, v6, s[44:47], 0 offen offset:32 nt
  buffer_load_ushort v35, v6, s[44:47], 0 offen offset:48 nt
  buffer_load_ushort v36, v6, s[44:47], 0 offen offset:64 nt
  buffer_load_ushort v37, v6, s[44:47], 0 offen offset:80 nt
  buffer_load_ushort v38, v6, s[44:47], 0 offen offset:96 nt
  buffer_load_ushort v39, v6, s[44:47], 0 offen offset:112 nt
  buffer_load_ushort v40, v6, s[44:47], 0 offen offset:128 nt
  buffer_load_ushort v41, v6, s[44:47], 0 offen offset:144 nt
  buffer_load_ushort v42, v6, s[44:47], 0 offen offset:160 nt
  buffer_load_ushort v43, v6, s[44:47], 0 offen offset:176 nt
  buffer_load_ushort v44, v6, s[44:47], 0 offen offset:192 nt
  buffer_load_ushort v45, v6, s[44:47], 0 offen offset:208 nt
  s_add_u32 s63, s60, 0
  buffer_load_dwordx4 v[64:67], v7, s[48:51], s63 offen nt
  s_add_u32 s63, s60, 28672
  buffer_load_dwordx4 v[68:71], v7, s[48:51], s63 offen nt
  s_add_u32 s63, s60, 57344
  buffer_load_dwordx4 v[72:75], v7, s[48:51], s63 offen nt
  s_add_u32 s63, s60, 86016
  buffer_load_dwordx4 v[76:79], v7, s[48:51], s63 offen nt
  s_add_u32 s63, s60, 114688
  buffer_load_dwordx4 v[80:83], v7, s[48:51], s63 offen nt
  s_add_u32 s63, s60, 143360
  buffer_load_dwordx4 v[84:87], v7, s[48:51], s63 offen nt
  s_add_u32 s63, s60, 172032
  buffer_load_dwordx4 v[88:91], v7, s[48:51], s63 offen nt
  s_add_u32 s63, s60, 200704
  buffer_load_dwordx4 v[92:95], v7, s[48:51], s63 offen nt
  s_add_u32 s63, s60, 229376
  buffer_load_dwordx4 v[96:99], v7, s[48:51], s63 offen nt
  s_add_u32 s63, s60, 258048
  buffer_load_dwordx4 v[100:103], v7, s[48:51], s63 offen nt
  s_add_u32 s63, s60, 286720
  buffer_load_dwordx4 v[104:107], v7, s[48:51], s63 offen nt
  s_add_u32 s63, s60, 315392
  buffer_load_dwordx4 v[108:111], v7, s[48:51], s63 offen nt
  s_add_u32 s63, s60, 344064
  buffer_load_dwordx4 v[112:115], v7, s[48:51], s63 offen nt
  s_add_u32 s63, s60, 372736
  buffer_load_dwordx4 v[116:119], v7, s[48:51], s63 offen nt
  s_waitcnt vmcnt(14)
  v_lshlrev_b32 v32, 16, v32
  v_lshlrev_b32 v33, 16, v33
  v_lshlrev_b32 v34, 16, v34
  v_lshlrev_b32 v35, 16, v35
  v_lshlrev_b32 v36, 16, v36
  v_lshlrev_b32 v37, 16, v37
  v_lshlrev_b32 v38, 16, v38
  v_lshlrev_b32 v39, 16, v39
  v_lshlrev_b32 v40, 16, v40
  v_lshlrev_b32 v41, 16, v41
  v_lshlrev_b32 v42, 16, v42
  v_lshlrev_b32 v43, 16, v43
  v_lshlrev_b32 v44, 16, v44
  v_lshlrev_b32 v45, 16, v45
  s_waitcnt vmcnt(0)
  v_mov_b32 v16, 0
  v_mov_b32 v17, 0
  v_mov_b32 v18, 0
  v_mov_b32 v19, 0
  v_mov_b32 v20, 0
  v_mov_b32 v21, 0
  v_mov_b32 v22, 0
  v_mov_b32 v23, 0
  v_lshlrev_b32 v28, 16, v64
  v_and_b32 v29, s55, v64
  v_fmac_f32 v16, v28, v32
  v_fmac_f32 v17, v29, v32
  v_lshlrev_b32 v28, 16, v65
  v_and_b32 v29, s55, v65
  v_fmac_f32 v18, v28, v32
  v_fmac_f32 v19, v29, v32
  v_lshlrev_b32 v28, 16, v66
  v_and_b32 v29, s55, v66
  v_fmac_f32 v20, v28, v32
  v_fmac_f32 v21, v29, v32
  v_lshlrev_b32 v28, 16, v67
  v_and_b32 v29, s55, v67
  v_fmac_f32 v22, v28, v32
  v_fmac_f32 v23, v29, v32
  v_lshlrev_b32 v28, 16, v68
  v_and_b32 v29, s55, v68
  v_fmac_f32 v16, v28, v33
  v_fmac_f32 v17, v29, v33
  v_lshlrev_b32 v28, 16, v69
  v_and_b32 v29, s55, v69
  v_fmac_f32 v18, v28, v33
  v_fmac_f32 v19, v29, v33
  v_lshlrev_b32 v28, 16, v70
  v_and_b32 v29, s55, v70
  v_fmac_f32 v20, v28, v33
  v_fmac_f32 v21, v29, v33
  v_lshlrev_b32 v28, 16, v71
  v_and_b32 v29, s55, v71
  v_fmac_f32 v22, v28, v33
  v_fmac_f32 v23, v29, v33
  v_lshlrev_b32 v28, 16, v72
  v_and_b32 v29, s55, v72
  v_fmac_f32 v16, v28, v34
  v_fmac_f32 v17, v29, v34
  v_lshlrev_b32 v28, 16, v73
  v_and_b32 v29, s55, v73
  v_fmac_f32 v18, v28, v34
  v_fmac_f32 v19, v29, v34
  v_lshlrev_b32 v28, 16, v74
  v_and_b32 v29, s55, v74
  v_fmac_f32 v20, v28, v34
  v_fmac_f32 v21, v29, v34
  v_lshlrev_b32 v28, 16, v75
  v_and_b32 v29, s55, v75
  v_fmac_f32 v22, v28, v34
  v_fmac_f32 v23, v29, v34
  v_lshlrev_b32 v28, 16, v76
  v_and_b32 v29, s55, v76
  v_fmac_f32 v16, v28, v35
  v_fmac_f32 v17, v29, v35
  v_lshlrev_b32 v28, 16, v77
  v_and_b32 v29, s55, v77
  v_fmac_f32 v18, v28, v35
  v_fmac_f32 v19, v29, v35
  v_lshlrev_b32 v28, 16, v78
  v_and_b32 v29, s55, v78
  v_fmac_f32 v20, v28, v35
  v_fmac_f32 v21, v29, v35
  v_lshlrev_b32 v28, 16, v79
  v_and_b32 v29, s55, v79
  v_fmac_f32 v22, v28, v35
  v_fmac_f32 v23, v29, v35
  v_lshlrev_b32 v28, 16, v80
  v_and_b32 v29, s55, v80
  v_fmac_f32 v16, v28, v36
  v_fmac_f32 v17, v29, v36
  v_lshlrev_b32 v28, 16, v81
  v_and_b32 v29, s55, v81
  v_fmac_f32 v18, v28, v36
  v_fmac_f32 v19, v29, v36
  v_lshlrev_b32 v28, 16, v82
  v_and_b32 v29, s55, v82
  v_fmac_f32 v20, v28, v36
  v_fmac_f32 v21, v29, v36
  v_lshlrev_b32 v28, 16, v83
  v_and_b32 v29, s55, v83
  v_fmac_f32 v22, v28, v36
  v_fmac_f32 v23, v29, v36
  v_lshlrev_b32 v28, 16, v84
  v_and_b32 v29, s55, v84
  v_fmac_f32 v16, v28, v37
  v_fmac_f32 v17, v29, v37
  v_lshlrev_b32 v28, 16, v85
  v_and_b32 v29, s55, v85
  v_fmac_f32 v18, v28, v37
  v_fmac_f32 v19, v29, v37
  v_lshlrev_b32 v28, 16, v86
  v_and_b32 v29, s55, v86
  v_fmac_f32 v20, v28, v37
  v_fmac_f32 v21, v29, v37
  v_lshlrev_b32 v28, 16, v87
  v_and_b32 v29, s55, v87
  v_fmac_f32 v22, v28, v37
  v_fmac_f32 v23, v29, v37
  v_lshlrev_b32 v28, 16, v88
  v_and_b32 v29, s55, v88
  v_fmac_f32 v16, v28, v38
  v_fmac_f32 v17, v29, v38
  v_lshlrev_b32 v28, 16, v89
  v_and_b32 v29, s55, v89
  v_fmac_f32 v18, v28, v38
  v_fmac_f32 v19, v29, v38
  v_lshlrev_b32 v28, 16, v90
  v_and_b32 v29, s55, v90
  v_fmac_f32 v20, v28, v38
  v_fmac_f32 v21, v29, v38
  v_lshlrev_b32 v28, 16, v91
  v_and_b32 v29, s55, v91
  v_fmac_f32 v22, v28, v38
  v_fmac_f32 v23, v29, v38
  v_lshlrev_b32 v28, 16, v92
  v_and_b32 v29, s55, v92
  v_fmac_f32 v16, v28, v39
  v_fmac_f32 v17, v29, v39
  v_lshlrev_b32 v28, 16, v93
  v_and_b32 v29, s55, v93
  v_fmac_f32 v18, v28, v39
  v_fmac_f32 v19, v29, v39
  v_lshlrev_b32 v28, 16, v94
  v_and_b32 v29, s55, v94
  v_fmac_f32 v20, v28, v39
  v_fmac_f32 v21, v29, v39
  v_lshlrev_b32 v28, 16, v95
  v_and_b32 v29, s55, v95
  v_fmac_f32 v22, v28, v39
  v_fmac_f32 v23, v29, v39
  v_lshlrev_b32 v28, 16, v96
  v_and_b32 v29, s55, v96
  v_fmac_f32 v16, v28, v40
  v_fmac_f32 v17, v29, v40
  v_lshlrev_b32 v28, 16, v97
  v_and_b32 v29, s55, v97
  v_fmac_f32 v18, v28, v40
  v_fmac_f32 v19, v29, v40
  v_lshlrev_b32 v28, 16, v98
  v_and_b32 v29, s55, v98
  v_fmac_f32 v20, v28, v40
  v_fmac_f32 v21, v29, v40
  v_lshlrev_b32 v28, 16, v99
  v_and_b32 v29, s55, v99
  v_fmac_f32 v22, v28, v40
  v_fmac_f32 v23, v29, v40
  v_lshlrev_b32 v28, 16, v100
  v_and_b32 v29, s55, v100
  v_fmac_f32 v16, v28, v41
  v_fmac_f32 v17, v29, v41
  v_lshlrev_b32 v28, 16, v101
  v_and_b32 v29, s55, v101
  v_fmac_f32 v18, v28, v41
  v_fmac_f32 v19, v29, v41
  v_lshlrev_b32 v28, 16, v102
  v_and_b32 v29, s55, v102
  v_fmac_f32 v20, v28, v41
  v_fmac_f32 v21, v29, v41
  v_lshlrev_b32 v28, 16, v103
  v_and_b32 v29, s55, v103
  v_fmac_f32 v22, v28, v41
  v_fmac_f32 v23, v29, v41
  v_lshlrev_b32 v28, 16, v104
  v_and_b32 v29, s55, v104
  v_fmac_f32 v16, v28, v42
  v_fmac_f32 v17, v29, v42
  v_lshlrev_b32 v28, 16, v105
  v_and_b32 v29, s55, v105
  v_fmac_f32 v18, v28, v42
  v_fmac_f32 v19, v29, v42
  v_lshlrev_b32 v28, 16, v106
  v_and_b32 v29, s55, v106
  v_fmac_f32 v20, v28, v42
  v_fmac_f32 v21, v29, v42
  v_lshlrev_b32 v28, 16, v107
  v_and_b32 v29, s55, v107
  v_fmac_f32 v22, v28, v42
  v_fmac_f32 v23, v29, v42
  v_lshlrev_b32 v28, 16, v108
  v_and_b32 v29, s55, v108
  v_fmac_f32 v16, v28, v43
  v_fmac_f32 v17, v29, v43
  v_lshlrev_b32 v28, 16, v109
  v_and_b32 v29, s55, v109
  v_fmac_f32 v18, v28, v43
  v_fmac_f32 v19, v29, v43
  v_lshlrev_b32 v28, 16, v110
  v_and_b32 v29, s55, v110
  v_fmac_f32 v20, v28, v43
  v_fmac_f32 v21, v29, v43
  v_lshlrev_b32 v28, 16, v111
  v_and_b32 v29, s55, v111
  v_fmac_f32 v22, v28, v43
  v_fmac_f32 v23, v29, v43
  v_lshlrev_b32 v28, 16, v112
  v_and_b32 v29, s55, v112
  v_fmac_f32 v16, v28, v44
  v_fmac_f32 v17, v29, v44
  v_lshlrev_b32 v28, 16, v113
  v_and_b32 v29, s55, v113
  v_fmac_f32 v18, v28, v44
  v_fmac_f32 v19, v29, v44
  v_lshlrev_b32 v28, 16, v114
  v_and_b32 v29, s55, v114
  v_fmac_f32 v20, v28, v44
  v_fmac_f32 v21, v29, v44
  v_lshlrev_b32 v28, 16, v115
  v_and_b32 v29, s55, v115
  v_fmac_f32 v22, v28, v44
  v_fmac_f32 v23, v29, v44
  v_lshlrev_b32 v28, 16, v116
  v_and_b32 v29, s55, v116
  v_fmac_f32 v16, v28, v45
  v_fmac_f32 v17, v29, v45
  v_lshlrev_b32 v28, 16, v117
  v_and_b32 v29, s55, v117
  v_fmac_f32 v18, v28, v45
  v_fmac_f32 v19, v29, v45
  v_lshlrev_b32 v28, 16, v118
  v_and_b32 v29, s55, v118
  v_fmac_f32 v20, v28, v45
  v_fmac_f32 v21, v29, v45
  v_lshlrev_b32 v28, 16, v119
  v_and_b32 v29, s55, v119
  v_fmac_f32 v22, v28, v45
  v_fmac_f32 v23, v29, v45
  buffer_load_ushort v32, v6, s[44:47], 0 offen offset:224 nt
  buffer_load_ushort v33, v6, s[44:47], 0 offen offset:240 nt
  buffer_load_ushort v34, v6, s[44:47], 0 offen offset:256 nt
  buffer_load_ushort v35, v6, s[44:47], 0 offen offset:272 nt
  buffer_load_ushort v36, v6, s[44:47], 0 offen offset:288 nt
  buffer_load_ushort v37, v6, s[44:47], 0 offen offset:304 nt
  buffer_load_ushort v38, v6, s[44:47], 0 offen offset:320 nt
  buffer_load_ushort v39, v6, s[44:47], 0 offen offset:336 nt
  buffer_load_ushort v40, v6, s[44:47], 0 offen offset:352 nt
  buffer_load_ushort v41, v6, s[44:47], 0 offen offset:368 nt
  buffer_load_ushort v42, v6, s[44:47], 0 offen offset:384 nt
  buffer_load_ushort v43, v6, s[44:47], 0 offen offset:400 nt
  buffer_load_ushort v44, v6, s[44:47], 0 offen offset:416 nt
  buffer_load_ushort v45, v6, s[44:47], 0 offen offset:432 nt
  s_add_u32 s60, s60, 401408
  s_add_u32 s63, s60, 0
  buffer_load_dwordx4 v[64:67], v7, s[48:51], s63 offen nt
  s_add_u32 s63, s60, 28672
  buffer_load_dwordx4 v[68:71], v7, s[48:51], s63 offen nt
  s_add_u32 s63, s60, 57344
  buffer_load_dwordx4 v[72:75], v7, s[48:51], s63 offen nt
  s_add_u32 s63, s60, 86016
  buffer_load_dwordx4 v[76:79], v7, s[48:51], s63 offen nt
  s_add_u32 s63, s60, 114688
  buffer_load_dwordx4 v[80:83], v7, s[48:51], s63 offen nt
  s_add_u32 s63, s60, 143360
  buffer_load_dwordx4 v[84:87], v7, s[48:51], s63 offen nt
  s_add_u32 s63, s60, 172032
  buffer_load_dwordx4 v[88:91], v7, s[48:51], s63 offen nt
  s_add_u32 s63, s60, 200704
  buffer_load_dwordx4 v[92:95], v7, s[48:51], s63 offen nt
  s_add_u32 s63, s60, 229376
  buffer_load_dwordx4 v[96:99], v7, s[48:51], s63 offen nt
  s_add_u32 s63, s60, 258048
  buffer_load_dwordx4 v[100:103], v7, s[48:51], s63 offen nt
  s_add_u32 s63, s60, 286720
  buffer_load_dwordx4 v[104:107], v7, s[48:51], s63 offen nt
  s_add_u32 s63, s60, 315392
  buffer_load_dwordx4 v[108:111], v7, s[48:51], s63 offen nt
  s_add_u32 s63, s60, 344064
  buffer_load_dwordx4 v[112:115], v7, s[48:51], s63 offen nt
  s_add_u32 s63, s60, 372736
  buffer_load_dwordx4 v[116:119], v7, s[48:51], s63 offen nt
  s_waitcnt vmcnt(14)
  v_lshlrev_b32 v32, 16, v32
  v_lshlrev_b32 v33, 16, v33
  v_lshlrev_b32 v34, 16, v34
  v_lshlrev_b32 v35, 16, v35
  v_lshlrev_b32 v36, 16, v36
  v_lshlrev_b32 v37, 16, v37
  v_lshlrev_b32 v38, 16, v38
  v_lshlrev_b32 v39, 16, v39
  v_lshlrev_b32 v40, 16, v40
  v_lshlrev_b32 v41, 16, v41
  v_lshlrev_b32 v42, 16, v42
  v_lshlrev_b32 v43, 16, v43
  v_lshlrev_b32 v44, 16, v44
  v_lshlrev_b32 v45, 16, v45
  s_waitcnt vmcnt(0)
  v_lshlrev_b32 v28, 16, v64
  v_and_b32 v29, s55, v64
  v_fmac_f32 v16, v28, v32
  v_fmac_f32 v17, v29, v32
  v_lshlrev_b32 v28, 16, v65
  v_and_b32 v29, s55, v65
  v_fmac_f32 v18, v28, v32
  v_fmac_f32 v19, v29, v32
  v_lshlrev_b32 v28, 16, v66
  v_and_b32 v29, s55, v66
  v_fmac_f32 v20, v28, v32
  v_fmac_f32 v21, v29, v32
  v_lshlrev_b32 v28, 16, v67
  v_and_b32 v29, s55, v67
  v_fmac_f32 v22, v28, v32
  v_fmac_f32 v23, v29, v32
  v_lshlrev_b32 v28, 16, v68
  v_and_b32 v29, s55, v68
  v_fmac_f32 v16, v28, v33
  v_fmac_f32 v17, v29, v33
  v_lshlrev_b32 v28, 16, v69
  v_and_b32 v29, s55, v69
  v_fmac_f32 v18, v28, v33
  v_fmac_f32 v19, v29, v33
  v_lshlrev_b32 v28, 16, v70
  v_and_b32 v29, s55, v70
  v_fmac_f32 v20, v28, v33
  v_fmac_f32 v21, v29, v33
  v_lshlrev_b32 v28, 16, v71
  v_and_b32 v29, s55, v71
  v_fmac_f32 v22, v28, v33
  v_fmac_f32 v23, v29, v33
  v_lshlrev_b32 v28, 16, v72
  v_and_b32 v29, s55, v72
  v_fmac_f32 v16, v28, v34
  v_fmac_f32 v17, v29, v34
  v_lshlrev_b32 v28, 16, v73
  v_and_b32 v29, s55, v73
  v_fmac_f32 v18, v28, v34
  v_fmac_f32 v19, v29, v34
  v_lshlrev_b32 v28, 16, v74
  v_and_b32 v29, s55, v74
  v_fmac_f32 v20, v28, v34
  v_fmac_f32 v21, v29, v34
  v_lshlrev_b32 v28, 16, v75
  v_and_b32 v29, s55, v75
  v_fmac_f32 v22, v28, v34
  v_fmac_f32 v23, v29, v34
  v_lshlrev_b32 v28, 16, v76
  v_and_b32 v29, s55, v76
  v_fmac_f32 v16, v28, v35
  v_fmac_f32 v17, v29, v35
  v_lshlrev_b32 v28, 16, v77
  v_and_b32 v29, s55, v77
  v_fmac_f32 v18, v28, v35
  v_fmac_f32 v19, v29, v35
  v_lshlrev_b32 v28, 16, v78
  v_and_b32 v29, s55, v78
  v_fmac_f32 v20, v28, v35
  v_fmac_f32 v21, v29, v35
  v_lshlrev_b32 v28, 16, v79
  v_and_b32 v29, s55, v79
  v_fmac_f32 v22, v28, v35
  v_fmac_f32 v23, v29, v35
  v_lshlrev_b32 v28, 16, v80
  v_and_b32 v29, s55, v80
  v_fmac_f32 v16, v28, v36
  v_fmac_f32 v17, v29, v36
  v_lshlrev_b32 v28, 16, v81
  v_and_b32 v29, s55, v81
  v_fmac_f32 v18, v28, v36
  v_fmac_f32 v19, v29, v36
  v_lshlrev_b32 v28, 16, v82
  v_and_b32 v29, s55, v82
  v_fmac_f32 v20, v28, v36
  v_fmac_f32 v21, v29, v36
  v_lshlrev_b32 v28, 16, v83
  v_and_b32 v29, s55, v83
  v_fmac_f32 v22, v28, v36
  v_fmac_f32 v23, v29, v36
  v_lshlrev_b32 v28, 16, v84
  v_and_b32 v29, s55, v84
  v_fmac_f32 v16, v28, v37
  v_fmac_f32 v17, v29, v37
  v_lshlrev_b32 v28, 16, v85
  v_and_b32 v29, s55, v85
  v_fmac_f32 v18, v28, v37
  v_fmac_f32 v19, v29, v37
  v_lshlrev_b32 v28, 16, v86
  v_and_b32 v29, s55, v86
  v_fmac_f32 v20, v28, v37
  v_fmac_f32 v21, v29, v37
  v_lshlrev_b32 v28, 16, v87
  v_and_b32 v29, s55, v87
  v_fmac_f32 v22, v28, v37
  v_fmac_f32 v23, v29, v37
  v_lshlrev_b32 v28, 16, v88
  v_and_b32 v29, s55, v88
  v_fmac_f32 v16, v28, v38
  v_fmac_f32 v17, v29, v38
  v_lshlrev_b32 v28, 16, v89
  v_and_b32 v29, s55, v89
  v_fmac_f32 v18, v28, v38
  v_fmac_f32 v19, v29, v38
  v_lshlrev_b32 v28, 16, v90
  v_and_b32 v29, s55, v90
  v_fmac_f32 v20, v28, v38
  v_fmac_f32 v21, v29, v38
  v_lshlrev_b32 v28, 16, v91
  v_and_b32 v29, s55, v91
  v_fmac_f32 v22, v28, v38
  v_fmac_f32 v23, v29, v38
  v_lshlrev_b32 v28, 16, v92
  v_and_b32 v29, s55, v92
  v_fmac_f32 v16, v28, v39
  v_fmac_f32 v17, v29, v39
  v_lshlrev_b32 v28, 16, v93
  v_and_b32 v29, s55, v93
  v_fmac_f32 v18, v28, v39
  v_fmac_f32 v19, v29, v39
  v_lshlrev_b32 v28, 16, v94
  v_and_b32 v29, s55, v94
  v_fmac_f32 v20, v28, v39
  v_fmac_f32 v21, v29, v39
  v_lshlrev_b32 v28, 16, v95
  v_and_b32 v29, s55, v95
  v_fmac_f32 v22, v28, v39
  v_fmac_f32 v23, v29, v39
  v_lshlrev_b32 v28, 16, v96
  v_and_b32 v29, s55, v96
  v_fmac_f32 v16, v28, v40
  v_fmac_f32 v17, v29, v40
  v_lshlrev_b32 v28, 16, v97
  v_and_b32 v29, s55, v97
  v_fmac_f32 v18, v28, v40
  v_fmac_f32 v19, v29, v40
  v_lshlrev_b32 v28, 16, v98
  v_and_b32 v29, s55, v98
  v_fmac_f32 v20, v28, v40
  v_fmac_f32 v21, v29, v40
  v_lshlrev_b32 v28, 16, v99
  v_and_b32 v29, s55, v99
  v_fmac_f32 v22, v28, v40
  v_fmac_f32 v23, v29, v40
  v_lshlrev_b32 v28, 16, v100
  v_and_b32 v29, s55, v100
  v_fmac_f32 v16, v28, v41
  v_fmac_f32 v17, v29, v41
  v_lshlrev_b32 v28, 16, v101
  v_and_b32 v29, s55, v101
  v_fmac_f32 v18, v28, v41
  v_fmac_f32 v19, v29, v41
  v_lshlrev_b32 v28, 16, v102
  v_and_b32 v29, s55, v102
  v_fmac_f32 v20, v28, v41
  v_fmac_f32 v21, v29, v41
  v_lshlrev_b32 v28, 16, v103
  v_and_b32 v29, s55, v103
  v_fmac_f32 v22, v28, v41
  v_fmac_f32 v23, v29, v41
  v_lshlrev_b32 v28, 16, v104
  v_and_b32 v29, s55, v104
  v_fmac_f32 v16, v28, v42
  v_fmac_f32 v17, v29, v42
  v_lshlrev_b32 v28, 16, v105
  v_and_b32 v29, s55, v105
  v_fmac_f32 v18, v28, v42
  v_fmac_f32 v19, v29, v42
  v_lshlrev_b32 v28, 16, v106
  v_and_b32 v29, s55, v106
  v_fmac_f32 v20, v28, v42
  v_fmac_f32 v21, v29, v42
  v_lshlrev_b32 v28, 16, v107
  v_and_b32 v29, s55, v107
  v_fmac_f32 v22, v28, v42
  v_fmac_f32 v23, v29, v42
  v_lshlrev_b32 v28, 16, v108
  v_and_b32 v29, s55, v108
  v_fmac_f32 v16, v28, v43
  v_fmac_f32 v17, v29, v43
  v_lshlrev_b32 v28, 16, v109
  v_and_b32 v29, s55, v109
  v_fmac_f32 v18, v28, v43
  v_fmac_f32 v19, v29, v43
  v_lshlrev_b32 v28, 16, v110
  v_and_b32 v29, s55, v110
  v_fmac_f32 v20, v28, v43
  v_fmac_f32 v21, v29, v43
  v_lshlrev_b32 v28, 16, v111
  v_and_b32 v29, s55, v111
  v_fmac_f32 v22, v28, v43
  v_fmac_f32 v23, v29, v43
  v_lshlrev_b32 v28, 16, v112
  v_and_b32 v29, s55, v112
  v_fmac_f32 v16, v28, v44
  v_fmac_f32 v17, v29, v44
  v_lshlrev_b32 v28, 16, v113
  v_and_b32 v29, s55, v113
  v_fmac_f32 v18, v28, v44
  v_fmac_f32 v19, v29, v44
  v_lshlrev_b32 v28, 16, v114
  v_and_b32 v29, s55, v114
  v_fmac_f32 v20, v28, v44
  v_fmac_f32 v21, v29, v44
  v_lshlrev_b32 v28, 16, v115
  v_and_b32 v29, s55, v115
  v_fmac_f32 v22, v28, v44
  v_fmac_f32 v23, v29, v44
  v_lshlrev_b32 v28, 16, v116
  v_and_b32 v29, s55, v116
  v_fmac_f32 v16, v28, v45
  v_fmac_f32 v17, v29, v45
  v_lshlrev_b32 v28, 16, v117
  v_and_b32 v29, s55, v117
  v_fmac_f32 v18, v28, v45
  v_fmac_f32 v19, v29, v45
  v_lshlrev_b32 v28, 16, v118
  v_and_b32 v29, s55, v118
  v_fmac_f32 v20, v28, v45
  v_fmac_f32 v21, v29, v45
  v_lshlrev_b32 v28, 16, v119
  v_and_b32 v29, s55, v119
  v_fmac_f32 v22, v28, v45
  v_fmac_f32 v23, v29, v45
  v_add_f32_dpp v16, v16, v16 row_ror:8 row_mask:0xf bank_mask:0xf
  v_add_f32_dpp v17, v17, v17 row_ror:8 row_mask:0xf bank_mask:0xf
  v_add_f32_dpp v18, v18, v18 row_ror:8 row_mask:0xf bank_mask:0xf
  v_add_f32_dpp v19, v19, v19 row_ror:8 row_mask:0xf bank_mask:0xf
  v_add_f32_dpp v20, v20, v20 row_ror:8 row_mask:0xf bank_mask:0xf
  v_add_f32_dpp v21, v21, v21 row_ror:8 row_mask:0xf bank_mask:0xf
  v_add_f32_dpp v22, v22, v22 row_ror:8 row_mask:0xf bank_mask:0xf
  v_add_f32_dpp v23, v23, v23 row_ror:8 row_mask:0xf bank_mask:0xf
  v_mov_b32 v48, v16
  v_mov_b32 v49, v17
  v_mov_b32 v50, v18
  v_mov_b32 v51, v19
  v_mov_b32 v52, v20
  v_mov_b32 v53, v21
  v_mov_b32 v54, v22
  v_mov_b32 v55, v23
  s_nop 1
  v_permlane16_swap_b32 v16, v48
  v_permlane16_swap_b32 v17, v49
  v_permlane16_swap_b32 v18, v50
  v_permlane16_swap_b32 v19, v51
  v_permlane16_swap_b32 v20, v52
  v_permlane16_swap_b32 v21, v53
  v_permlane16_swap_b32 v22, v54
  v_permlane16_swap_b32 v23, v55
  s_nop 1
  v_add_f32 v16, v16, v48
  v_add_f32 v17, v17, v49
  v_add_f32 v18, v18, v50
  v_add_f32 v19, v19, v51
  v_add_f32 v20, v20, v52
  v_add_f32 v21, v21, v53
  v_add_f32 v22, v22, v54
  v_add_f32 v23, v23, v55
  v_mov_b32 v48, v16
  v_mov_b32 v49, v17
  v_mov_b32 v50, v18
  v_mov_b32 v51, v19
  v_mov_b32 v52, v20
  v_mov_b32 v53, v21
  v_mov_b32 v54, v22
  v_mov_b32 v55, v23
  s_nop 1
  v_permlane32_swap_b32 v16, v48
  v_permlane32_swap_b32 v17, v49
  v_permlane32_swap_b32 v18, v50
  v_permlane32_swap_b32 v19, v51
  v_permlane32_swap_b32 v20, v52
  v_permlane32_swap_b32 v21, v53
  v_permlane32_swap_b32 v22, v54
  v_permlane32_swap_b32 v23, v55
  s_nop 1
  v_add_f32 v16, v16, v48
  v_add_f32 v17, v17, v49
  v_add_f32 v18, v18, v50
  v_add_f32 v19, v19, v51
  v_add_f32 v20, v20, v52
  v_add_f32 v21, v21, v53
  v_add_f32 v22, v22, v54
  v_add_f32 v23, v23, v55
  s_mul_i32 s60, s59, 28
  s_add_u32 s60, s60, s58
  s_lshl_b32 s60, s60, 1
  s_add_u32 s60, s60, s57
  s_lshl_b32 s60, s60, 9
  s_add_u32 s60, s60, 1310720
  s_nop 1
  v_lshlrev_b32 v30, 6, v0
  v_mov_b32 v48, v16
  v_mov_b32 v49, s62
  v_mov_b32 v50, v17
  v_mov_b32 v51, s62
  ds_write_b128 v30, v[48:51] offset:2048
  v_mov_b32 v52, v18
  v_mov_b32 v53, s62
  v_mov_b32 v54, v19
  v_mov_b32 v55, s62
  ds_write_b128 v30, v[52:55] offset:2064
  v_mov_b32 v56, v20
  v_mov_b32 v57, s62
  v_mov_b32 v58, v21
  v_mov_b32 v59, s62
  ds_write_b128 v30, v[56:59] offset:2080
  v_mov_b32 v60, v22
  v_mov_b32 v61, s62
  v_mov_b32 v62, v23
  v_mov_b32 v63, s62
  ds_write_b128 v30, v[60:63] offset:2096
  v_lshrrev_b32 v28, 2, v0
  s_mov_b32 s63, 64
  v_mul_lo_u32 v28, v28, s63
  v_and_b32 v29, 3, v0
  v_lshl_add_u32 v28, v29, 4, v28
  s_waitcnt lgkmcnt(0)
  ds_read_b128 v[48:51], v1 offset:2048
  s_waitcnt lgkmcnt(0)
  s_add_u32 s63, s60, 0
  s_mov_b32 s64, 0xffffffff
  s_mov_b32 s65, 0x0
  s_mov_b64 exec, s[64:65]
  buffer_store_dwordx4 v[48:51], v28, s[40:43], s63 offen sc1
  s_mov_b64 exec, -1
L_noffn1:
  s_mov_b32 s56, s22
  s_mov_b32 s57, s23
  s_mov_b32 s58, 896
  s_mov_b32 s59, 0x00020000
  buffer_load_dwordx4 v[8:11], v1, s[44:47], 0 offen nt
  buffer_load_dwordx4 v[12:15], v1, s[56:59], 0 offen nt
  s_waitcnt vmcnt(0)
  v_mov_b32 v16, 0
  v_lshlrev_b32 v24, 16, v8
  v_and_b32 v25, s55, v8
  v_lshlrev_b32 v26, 16, v12
  v_and_b32 v27, s55, v12
  v_mul_f32 v24, v24, v26
  v_mul_f32 v25, v25, v27
  v_cvt_pk_bf16_f32 v28, v24, v25
  v_lshlrev_b32 v24, 16, v28
  v_and_b32 v25, s55, v28
  v_add_f32 v16, v16, v24
  v_add_f32 v16, v16, v25
  v_lshlrev_b32 v24, 16, v9
  v_and_b32 v25, s55, v9
  v_lshlrev_b32 v26, 16, v13
  v_and_b32 v27, s55, v13
  v_mul_f32 v24, v24, v26
  v_mul_f32 v25, v25, v27
  v_cvt_pk_bf16_f32 v28, v24, v25
  v_lshlrev_b32 v24, 16, v28
  v_and_b32 v25, s55, v28
  v_add_f32 v16, v16, v24
  v_add_f32 v16, v16, v25
  v_lshlrev_b32 v24, 16, v10
  v_and_b32 v25, s55, v10
  v_lshlrev_b32 v26, 16, v14
  v_and_b32 v27, s55, v14
  v_mul_f32 v24, v24, v26
  v_mul_f32 v25, v25, v27
  v_cvt_pk_bf16_f32 v28, v24, v25
  v_lshlrev_b32 v24, 16, v28
  v_and_b32 v25, s55, v28
  v_add_f32 v16, v16, v24
  v_add_f32 v16, v16, v25
  v_lshlrev_b32 v24, 16, v11
  v_and_b32 v25, s55, v11
  v_lshlrev_b32 v26, 16, v15
  v_and_b32 v27, s55, v15
  v_mul_f32 v24, v24, v26
  v_mul_f32 v25, v25, v27
  v_cvt_pk_bf16_f32 v28, v24, v25
  v_lshlrev_b32 v24, 16, v28
  v_and_b32 v25, s55, v28
  v_add_f32 v16, v16, v24
  v_add_f32 v16, v16, v25
  s_nop 1
  v_add_f32_dpp v16, v16, v16 row_ror:1 row_mask:0xf bank_mask:0xf
  s_nop 1
  v_add_f32_dpp v16, v16, v16 row_ror:2 row_mask:0xf bank_mask:0xf
  s_nop 1
  v_add_f32_dpp v16, v16, v16 row_ror:4 row_mask:0xf bank_mask:0xf
  s_nop 1
  v_add_f32_dpp v16, v16, v16 row_ror:8 row_mask:0xf bank_mask:0xf
  s_nop 1
  v_mov_b32 v48, v16
  s_nop 1
  v_permlane16_swap_b32 v16, v48
  s_nop 1
  v_add_f32 v16, v16, v48
  s_nop 1
  v_mov_b32 v48, v16
  s_nop 1
  v_permlane32_swap_b32 v16, v48
  s_nop 1
  v_add_f32 v16, v16, v48
  v_cvt_pk_bf16_f32 v28, v16, v16
  v_lshlrev_b32 v16, 16, v28
  v_mul_f32 v16, 0xbfb8aa3b, v16
  v_exp_f32 v16, v16
  s_nop 0
  v_add_f32 v16, 1.0, v16
  v_rcp_f32 v16, v16
  s_nop 0
  v_cvt_pk_bf16_f32 v28, v16, v16
  v_lshlrev_b32 v16, 16, v28
  v_sub_f32 v17, 1.0, v16
  v_cvt_pk_bf16_f32 v28, v17, v17
  v_lshlrev_b32 v17, 16, v28
  v_mov_b32 v12, v16
  v_mov_b32 v13, v17
  s_cmp_ge_u32 s2, 224
  s_cbranch_scc1 L_noffn2
  s_cmp_lt_u32 s2, 112
  s_cbranch_scc1 L_noffn2
  s_sub_u32 s56, s2, 112
  s_mul_i32 s57, s56, 9363
  s_lshr_b32 s57, s57, 16
  s_mul_i32 s58, s57, 7
  s_sub_u32 s58, s56, s58
  s_mov_b32 s48, s20
  s_mov_b32 s49, s21
  s_mov_b32 s50, 1605632
  s_mov_b32 s51, 0x00020000
  v_lshrrev_b32 v9, 3, v0
  v_and_b32 v10, 7, v0
  s_mov_b32 s63, 896
  v_mul_lo_u32 v7, v9, s63
  v_lshl_add_u32 v7, v10, 4, v7
  s_mul_i32 s60, s57, 100352
  s_lshl_b32 s61, s58, 7
  s_add_u32 s60, s60, s61
  s_add_u32 s63, s60, 0
  buffer_load_dwordx4 v[64:67], v7, s[48:51], s63 offen nt
  s_add_u32 s63, s60, 7168
  buffer_load_dwordx4 v[68:71], v7, s[48:51], s63 offen nt
  s_add_u32 s63, s60, 14336
  buffer_load_dwordx4 v[72:75], v7, s[48:51], s63 offen nt
  s_add_u32 s63, s60, 21504
  buffer_load_dwordx4 v[76:79], v7, s[48:51], s63 offen nt
  s_add_u32 s63, s60, 28672
  buffer_load_dwordx4 v[80:83], v7, s[48:51], s63 offen nt
  s_add_u32 s63, s60, 35840
  buffer_load_dwordx4 v[84:87], v7, s[48:51], s63 offen nt
  s_add_u32 s63, s60, 43008
  buffer_load_dwordx4 v[88:91], v7, s[48:51], s63 offen nt
  s_add_u32 s63, s60, 50176
  buffer_load_dwordx4 v[92:95], v7, s[48:51], s63 offen nt
  s_add_u32 s63, s60, 57344
  buffer_load_dwordx4 v[96:99], v7, s[48:51], s63 offen nt
  s_add_u32 s63, s60, 64512
  buffer_load_dwordx4 v[100:103], v7, s[48:51], s63 offen nt
  s_add_u32 s63, s60, 71680
  buffer_load_dwordx4 v[104:107], v7, s[48:51], s63 offen nt
  s_add_u32 s63, s60, 78848
  buffer_load_dwordx4 v[108:111], v7, s[48:51], s63 offen nt
  s_add_u32 s63, s60, 86016
  buffer_load_dwordx4 v[112:115], v7, s[48:51], s63 offen nt
  s_add_u32 s63, s60, 93184
  buffer_load_dwordx4 v[116:119], v7, s[48:51], s63 offen nt
  v_min_u32 v8, 55, v0
  s_mul_i32 s59, s57, 112
  v_add_u32 v8, s59, v8
  v_add_u32 v6, 56, v8
  v_lshrrev_b32 v11, 6, v8
  v_lshlrev_b32 v11, 10, v11
  v_and_b32 v8, 63, v8
  v_lshl_add_u32 v8, v8, 3, v11
  v_lshrrev_b32 v11, 6, v6
  v_lshlrev_b32 v11, 10, v11
  v_and_b32 v6, 63, v6
  v_lshl_add_u32 v6, v6, 3, v11
  s_mov_b32 s56, 1310720
  s_mov_b32 s59, 1339392
  s_mov_b64 s[76:77], -1
  s_mov_b32 s70, 65536
L_poll_h:
  s_mov_b64 exec, s[76:77]
  s_cbranch_execz L_sk_h_0
  buffer_load_dwordx2 v[32:33], v8, s[40:43], s56 offen offset:0 sc1
  buffer_load_dwordx2 v[34:35], v8, s[40:43], s56 offen offset:512 sc1
  buffer_load_dwordx2 v[36:37], v8, s[40:43], s59 offen offset:0 sc1
  buffer_load_dwordx2 v[38:39], v8, s[40:43], s59 offen offset:512 sc1
  buffer_load_dwordx2 v[40:41], v6, s[40:43], s56 offen offset:0 sc1
  buffer_load_dwordx2 v[42:43], v6, s[40:43], s56 offen offset:512 sc1
  buffer_load_dwordx2 v[44:45], v6, s[40:43], s59 offen offset:0 sc1
  buffer_load_dwordx2 v[46:47], v6, s[40:43], s59 offen offset:512 sc1
L_sk_h_0:
  s_mov_b64 exec, -1
  s_waitcnt vmcnt(0)
  s_mov_b64 s[66:67], 0
  v_max3_u32 v20, v33, v35, v37
  v_max3_u32 v20, v20, v39, v41
  v_max3_u32 v20, v20, v43, v45
  v_max_u32 v20, v20, v47
  v_min3_u32 v21, v33, v35, v37
  v_min3_u32 v21, v21, v39, v41
  v_min3_u32 v21, v21, v43, v45
  v_min_u32 v21, v21, v47
  v_xor_b32 v20, s62, v20
  v_xor_b32 v21, s62, v21
  v_or_b32 v20, v20, v21
  v_cmp_ne_u32 vcc, 0, v20
  s_and_b64 s[76:77], s[76:77], vcc
  s_mov_b64 s[66:67], s[76:77]
  s_cmp_eq_u64 s[66:67], 0
  s_cbranch_scc1 L_ok_h
  s_sub_u32 s70, s70, 1
  s_cmp_eq_u32 s70, 0
  s_cbranch_scc1 L_fail_h
  s_sleep 32
  s_branch L_poll_h
L_fail_h:
  v_mov_b32 v28, 132
  v_mov_b32 v29, 1
  s_mov_b64 exec, 1
  global_atomic_add v28, v29, s[26:27]
  s_mov_b64 exec, -1
L_ok_h:
  v_add_f32 v16, v32, v34
  v_add_f32 v17, v36, v38
  v_add_f32 v18, v40, v42
  v_add_f32 v19, v44, v46
  v_cvt_pk_bf16_f32 v28, v16, v17
  v_lshlrev_b32 v16, 16, v28
  v_and_b32 v17, s55, v28
  v_cvt_pk_bf16_f32 v28, v18, v19
  v_lshlrev_b32 v18, 16, v28
  v_and_b32 v19, s55, v28
  v_max_f32 v16, 0, v16
  v_max_f32 v18, 0, v18
  v_mul_f32 v16, v16, v17
  v_mul_f32 v17, v18, v19
  v_cvt_pk_bf16_f32 v28, v16, v17
  v_lshlrev_b32 v16, 16, v28
  v_and_b32 v17, s55, v28
  v_lshlrev_b32 v9, 2, v9
  v_add_u32 v10, 0, v9
  ds_bpermute_b32 v32, v10, v16
  v_add_u32 v10, 32, v9
  ds_bpermute_b32 v33, v10, v16
  v_add_u32 v10, 64, v9
  ds_bpermute_b32 v34, v10, v16
  v_add_u32 v10, 96, v9
  ds_bpermute_b32 v35, v10, v16
  v_add_u32 v10, 128, v9
  ds_bpermute_b32 v36, v10, v16
  v_add_u32 v10, 160, v9
  ds_bpermute_b32 v37, v10, v16
  v_add_u32 v10, 192, v9
  ds_bpermute_b32 v38, v10, v16
  v_add_u32 v10, 0, v9
  ds_bpermute_b32 v39, v10, v17
  v_add_u32 v10, 32, v9
  ds_bpermute_b32 v40, v10, v17
  v_add_u32 v10, 64, v9
  ds_bpermute_b32 v41, v10, v17
  v_add_u32 v10, 96, v9
  ds_bpermute_b32 v42, v10, v17
  v_add_u32 v10, 128, v9
  ds_bpermute_b32 v43, v10, v17
  v_add_u32 v10, 160, v9
  ds_bpermute_b32 v44, v10, v17
  v_add_u32 v10, 192, v9
  ds_bpermute_b32 v45, v10, v17
  s_waitcnt lgkmcnt(0)
  v_mov_b32 v16, 0
  v_mov_b32 v17, 0
  v_mov_b32 v18, 0
  v_mov_b32 v19, 0
  v_mov_b32 v20, 0
  v_mov_b32 v21, 0
  v_mov_b32 v22, 0
  v_mov_b32 v23, 0
  v_lshlrev_b32 v28, 16, v64
  v_and_b32 v29, s55, v64
  v_fmac_f32 v16, v28, v32
  v_fmac_f32 v17, v29, v32
  v_lshlrev_b32 v28, 16, v65
  v_and_b32 v29, s55, v65
  v_fmac_f32 v18, v28, v32
  v_fmac_f32 v19, v29, v32
  v_lshlrev_b32 v28, 16, v66
  v_and_b32 v29, s55, v66
  v_fmac_f32 v20, v28, v32
  v_fmac_f32 v21, v29, v32
  v_lshlrev_b32 v28, 16, v67
  v_and_b32 v29, s55, v67
  v_fmac_f32 v22, v28, v32
  v_fmac_f32 v23, v29, v32
  v_lshlrev_b32 v28, 16, v68
  v_and_b32 v29, s55, v68
  v_fmac_f32 v16, v28, v33
  v_fmac_f32 v17, v29, v33
  v_lshlrev_b32 v28, 16, v69
  v_and_b32 v29, s55, v69
  v_fmac_f32 v18, v28, v33
  v_fmac_f32 v19, v29, v33
  v_lshlrev_b32 v28, 16, v70
  v_and_b32 v29, s55, v70
  v_fmac_f32 v20, v28, v33
  v_fmac_f32 v21, v29, v33
  v_lshlrev_b32 v28, 16, v71
  v_and_b32 v29, s55, v71
  v_fmac_f32 v22, v28, v33
  v_fmac_f32 v23, v29, v33
  v_lshlrev_b32 v28, 16, v72
  v_and_b32 v29, s55, v72
  v_fmac_f32 v16, v28, v34
  v_fmac_f32 v17, v29, v34
  v_lshlrev_b32 v28, 16, v73
  v_and_b32 v29, s55, v73
  v_fmac_f32 v18, v28, v34
  v_fmac_f32 v19, v29, v34
  v_lshlrev_b32 v28, 16, v74
  v_and_b32 v29, s55, v74
  v_fmac_f32 v20, v28, v34
  v_fmac_f32 v21, v29, v34
  v_lshlrev_b32 v28, 16, v75
  v_and_b32 v29, s55, v75
  v_fmac_f32 v22, v28, v34
  v_fmac_f32 v23, v29, v34
  v_lshlrev_b32 v28, 16, v76
  v_and_b32 v29, s55, v76
  v_fmac_f32 v16, v28, v35
  v_fmac_f32 v17, v29, v35
  v_lshlrev_b32 v28, 16, v77
  v_and_b32 v29, s55, v77
  v_fmac_f32 v18, v28, v35
  v_fmac_f32 v19, v29, v35
  v_lshlrev_b32 v28, 16, v78
  v_and_b32 v29, s55, v78
  v_fmac_f32 v20, v28, v35
  v_fmac_f32 v21, v29, v35
  v_lshlrev_b32 v28, 16, v79
  v_and_b32 v29, s55, v79
  v_fmac_f32 v22, v28, v35
  v_fmac_f32 v23, v29, v35
  v_lshlrev_b32 v28, 16, v80
  v_and_b32 v29, s55, v80
  v_fmac_f32 v16, v28, v36
  v_fmac_f32 v17, v29, v36
  v_lshlrev_b32 v28, 16, v81
  v_and_b32 v29, s55, v81
  v_fmac_f32 v18, v28, v36
  v_fmac_f32 v19, v29, v36
  v_lshlrev_b32 v28, 16, v82
  v_and_b32 v29, s55, v82
  v_fmac_f32 v20, v28, v36
  v_fmac_f32 v21, v29, v36
  v_lshlrev_b32 v28, 16, v83
  v_and_b32 v29, s55, v83
  v_fmac_f32 v22, v28, v36
  v_fmac_f32 v23, v29, v36
  v_lshlrev_b32 v28, 16, v84
  v_and_b32 v29, s55, v84
  v_fmac_f32 v16, v28, v37
  v_fmac_f32 v17, v29, v37
  v_lshlrev_b32 v28, 16, v85
  v_and_b32 v29, s55, v85
  v_fmac_f32 v18, v28, v37
  v_fmac_f32 v19, v29, v37
  v_lshlrev_b32 v28, 16, v86
  v_and_b32 v29, s55, v86
  v_fmac_f32 v20, v28, v37
  v_fmac_f32 v21, v29, v37
  v_lshlrev_b32 v28, 16, v87
  v_and_b32 v29, s55, v87
  v_fmac_f32 v22, v28, v37
  v_fmac_f32 v23, v29, v37
  v_lshlrev_b32 v28, 16, v88
  v_and_b32 v29, s55, v88
  v_fmac_f32 v16, v28, v38
  v_fmac_f32 v17, v29, v38
  v_lshlrev_b32 v28, 16, v89
  v_and_b32 v29, s55, v89
  v_fmac_f32 v18, v28, v38
  v_fmac_f32 v19, v29, v38
  v_lshlrev_b32 v28, 16, v90
  v_and_b32 v29, s55, v90
  v_fmac_f32 v20, v28, v38
  v_fmac_f32 v21, v29, v38
  v_lshlrev_b32 v28, 16, v91
  v_and_b32 v29, s55, v91
  v_fmac_f32 v22, v28, v38
  v_fmac_f32 v23, v29, v38
  v_lshlrev_b32 v28, 16, v92
  v_and_b32 v29, s55, v92
  v_fmac_f32 v16, v28, v39
  v_fmac_f32 v17, v29, v39
  v_lshlrev_b32 v28, 16, v93
  v_and_b32 v29, s55, v93
  v_fmac_f32 v18, v28, v39
  v_fmac_f32 v19, v29, v39
  v_lshlrev_b32 v28, 16, v94
  v_and_b32 v29, s55, v94
  v_fmac_f32 v20, v28, v39
  v_fmac_f32 v21, v29, v39
  v_lshlrev_b32 v28, 16, v95
  v_and_b32 v29, s55, v95
  v_fmac_f32 v22, v28, v39
  v_fmac_f32 v23, v29, v39
  v_lshlrev_b32 v28, 16, v96
  v_and_b32 v29, s55, v96
  v_fmac_f32 v16, v28, v40
  v_fmac_f32 v17, v29, v40
  v_lshlrev_b32 v28, 16, v97
  v_and_b32 v29, s55, v97
  v_fmac_f32 v18, v28, v40
  v_fmac_f32 v19, v29, v40
  v_lshlrev_b32 v28, 16, v98
  v_and_b32 v29, s55, v98
  v_fmac_f32 v20, v28, v40
  v_fmac_f32 v21, v29, v40
  v_lshlrev_b32 v28, 16, v99
  v_and_b32 v29, s55, v99
  v_fmac_f32 v22, v28, v40
  v_fmac_f32 v23, v29, v40
  v_lshlrev_b32 v28, 16, v100
  v_and_b32 v29, s55, v100
  v_fmac_f32 v16, v28, v41
  v_fmac_f32 v17, v29, v41
  v_lshlrev_b32 v28, 16, v101
  v_and_b32 v29, s55, v101
  v_fmac_f32 v18, v28, v41
  v_fmac_f32 v19, v29, v41
  v_lshlrev_b32 v28, 16, v102
  v_and_b32 v29, s55, v102
  v_fmac_f32 v20, v28, v41
  v_fmac_f32 v21, v29, v41
  v_lshlrev_b32 v28, 16, v103
  v_and_b32 v29, s55, v103
  v_fmac_f32 v22, v28, v41
  v_fmac_f32 v23, v29, v41
  v_lshlrev_b32 v28, 16, v104
  v_and_b32 v29, s55, v104
  v_fmac_f32 v16, v28, v42
  v_fmac_f32 v17, v29, v42
  v_lshlrev_b32 v28, 16, v105
  v_and_b32 v29, s55, v105
  v_fmac_f32 v18, v28, v42
  v_fmac_f32 v19, v29, v42
  v_lshlrev_b32 v28, 16, v106
  v_and_b32 v29, s55, v106
  v_fmac_f32 v20, v28, v42
  v_fmac_f32 v21, v29, v42
  v_lshlrev_b32 v28, 16, v107
  v_and_b32 v29, s55, v107
  v_fmac_f32 v22, v28, v42
  v_fmac_f32 v23, v29, v42
  v_lshlrev_b32 v28, 16, v108
  v_and_b32 v29, s55, v108
  v_fmac_f32 v16, v28, v43
  v_fmac_f32 v17, v29, v43
  v_lshlrev_b32 v28, 16, v109
  v_and_b32 v29, s55, v109
  v_fmac_f32 v18, v28, v43
  v_fmac_f32 v19, v29, v43
  v_lshlrev_b32 v28, 16, v110
  v_and_b32 v29, s55, v110
  v_fmac_f32 v20, v28, v43
  v_fmac_f32 v21, v29, v43
  v_lshlrev_b32 v28, 16, v111
  v_and_b32 v29, s55, v111
  v_fmac_f32 v22, v28, v43
  v_fmac_f32 v23, v29, v43
  v_lshlrev_b32 v28, 16, v112
  v_and_b32 v29, s55, v112
  v_fmac_f32 v16, v28, v44
  v_fmac_f32 v17, v29, v44
  v_lshlrev_b32 v28, 16, v113
  v_and_b32 v29, s55, v113
  v_fmac_f32 v18, v28, v44
  v_fmac_f32 v19, v29, v44
  v_lshlrev_b32 v28, 16, v114
  v_and_b32 v29, s55, v114
  v_fmac_f32 v20, v28, v44
  v_fmac_f32 v21, v29, v44
  v_lshlrev_b32 v28, 16, v115
  v_and_b32 v29, s55, v115
  v_fmac_f32 v22, v28, v44
  v_fmac_f32 v23, v29, v44
  v_lshlrev_b32 v28, 16, v116
  v_and_b32 v29, s55, v116
  v_fmac_f32 v16, v28, v45
  v_fmac_f32 v17, v29, v45
  v_lshlrev_b32 v28, 16, v117
  v_and_b32 v29, s55, v117
  v_fmac_f32 v18, v28, v45
  v_fmac_f32 v19, v29, v45
  v_lshlrev_b32 v28, 16, v118
  v_and_b32 v29, s55, v118
  v_fmac_f32 v20, v28, v45
  v_fmac_f32 v21, v29, v45
  v_lshlrev_b32 v28, 16, v119
  v_and_b32 v29, s55, v119
  v_fmac_f32 v22, v28, v45
  v_fmac_f32 v23, v29, v45
  v_add_f32_dpp v16, v16, v16 row_ror:8 row_mask:0xf bank_mask:0xf
  v_add_f32_dpp v17, v17, v17 row_ror:8 row_mask:0xf bank_mask:0xf
  v_add_f32_dpp v18, v18, v18 row_ror:8 row_mask:0xf bank_mask:0xf
  v_add_f32_dpp v19, v19, v19 row_ror:8 row_mask:0xf bank_mask:0xf
  v_add_f32_dpp v20, v20, v20 row_ror:8 row_mask:0xf bank_mask:0xf
  v_add_f32_dpp v21, v21, v21 row_ror:8 row_mask:0xf bank_mask:0xf
  v_add_f32_dpp v22, v22, v22 row_ror:8 row_mask:0xf bank_mask:0xf
  v_add_f32_dpp v23, v23, v23 row_ror:8 row_mask:0xf bank_mask:0xf
  v_mov_b32 v48, v16
  v_mov_b32 v49, v17
  v_mov_b32 v50, v18
  v_mov_b32 v51, v19
  v_mov_b32 v52, v20
  v_mov_b32 v53, v21
  v_mov_b32 v54, v22
  v_mov_b32 v55, v23
  s_nop 1
  v_permlane16_swap_b32 v16, v48
  v_permlane16_swap_b32 v17, v49
  v_permlane16_swap_b32 v18, v50
  v_permlane16_swap_b32 v19, v51
  v_permlane16_swap_b32 v20, v52
  v_permlane16_swap_b32 v21, v53
  v_permlane16_swap_b32 v22, v54
  v_permlane16_swap_b32 v23, v55
  s_nop 1
  v_add_f32 v16, v16, v48
  v_add_f32 v17, v17, v49
  v_add_f32 v18, v18, v50
  v_add_f32 v19, v19, v51
  v_add_f32 v20, v20, v52
  v_add_f32 v21, v21, v53
  v_add_f32 v22, v22, v54
  v_add_f32 v23, v23, v55
  v_mov_b32 v48, v16
  v_mov_b32 v49, v17
  v_mov_b32 v50, v18
  v_mov_b32 v51, v19
  v_mov_b32 v52, v20
  v_mov_b32 v53, v21
  v_mov_b32 v54, v22
  v_mov_b32 v55, v23
  s_nop 1
  v_permlane32_swap_b32 v16, v48
  v_permlane32_swap_b32 v17, v49
  v_permlane32_swap_b32 v18, v50
  v_permlane32_swap_b32 v19, v51
  v_permlane32_swap_b32 v20, v52
  v_permlane32_swap_b32 v21, v53
  v_permlane32_swap_b32 v22, v54
  v_permlane32_swap_b32 v23, v55
  s_nop 1
  v_add_f32 v16, v16, v48
  v_add_f32 v17, v17, v49
  v_add_f32 v18, v18, v50
  v_add_f32 v19, v19, v51
  v_add_f32 v20, v20, v52
  v_add_f32 v21, v21, v53
  v_add_f32 v22, v22, v54
  v_add_f32 v23, v23, v55
  s_lshl_b32 s58, s58, 4
  s_add_u32 s58, s58, s57
  s_lshl_b32 s58, s58, 9
  s_add_u32 s58, s58, 3145728
  s_nop 1
  v_lshlrev_b32 v30, 6, v0
  v_mov_b32 v48, v16
  v_mov_b32 v49, s62
  v_mov_b32 v50, v17
  v_mov_b32 v51, s62
  ds_write_b128 v30, v[48:51] offset:2048
  v_mov_b32 v52, v18
  v_mov_b32 v53, s62
  v_mov_b32 v54, v19
  v_mov_b32 v55, s62
  ds_write_b128 v30, v[52:55] offset:2064
  v_mov_b32 v56, v20
  v_mov_b32 v57, s62
  v_mov_b32 v58, v21
  v_mov_b32 v59, s62
  ds_write_b128 v30, v[56:59] offset:2080
  v_mov_b32 v60, v22
  v_mov_b32 v61, s62
  v_mov_b32 v62, v23
  v_mov_b32 v63, s62
  ds_write_b128 v30, v[60:63] offset:2096
  v_lshrrev_b32 v28, 2, v0
  s_mov_b32 s63, 64
  v_mul_lo_u32 v28, v28, s63
  v_and_b32 v29, 3, v0
  v_lshl_add_u32 v28, v29, 4, v28
  s_waitcnt lgkmcnt(0)
  ds_read_b128 v[48:51], v1 offset:2048
  s_waitcnt lgkmcnt(0)
  s_add_u32 s63, s58, 0
  s_mov_b32 s64, 0xffffffff
  s_mov_b32 s65, 0x0
  s_mov_b64 exec, s[64:65]
  buffer_store_dwordx4 v[48:51], v28, s[40:43], s63 offen sc1
  s_mov_b64 exec, -1
L_noffn2:
  s_cmp_ge_u32 s71, 56
  s_cbranch_scc1 L_nob
  s_lshr_b32 s58, s71, 3
  s_lshl_b32 s58, s58, 13
  s_and_b32 s57, s71, 7
  s_lshl_b32 s57, s57, 6
  s_add_u32 s58, s58, s57
  s_add_u32 s58, s58, 3145728
  v_lshrrev_b32 v8, 2, v0
  s_mov_b32 s63, 512
  v_mul_lo_u32 v8, v8, s63
  v_and_b32 v9, 3, v0
  v_lshl_add_u32 v8, v9, 4, v8
  s_mov_b64 s[76:77], -1
  s_mov_b32 s70, 65536
L_poll_b:
  s_mov_b64 exec, s[76:77]
  s_cbranch_execz L_sk_b_0
  s_add_u32 s84, s58, 0
  buffer_load_dwordx4 v[32:35], v8, s[40:43], s84 offen sc1
L_sk_b_0:
  s_mov_b64 exec, -1
  s_waitcnt vmcnt(0)
  s_mov_b64 s[66:67], 0
  v_cmp_eq_u32 s[68:69], s62, v33
  v_cmp_eq_u32 vcc, s62, v35
  s_and_b64 s[68:69], s[68:69], vcc
  s_andn2_b64 s[76:77], s[76:77], s[68:69]
  s_or_b64 s[66:67], s[66:67], s[76:77]
  s_cmp_eq_u64 s[66:67], 0
  s_cbranch_scc1 L_ok_b
  s_sub_u32 s70, s70, 1
  s_cmp_eq_u32 s70, 0
  s_cbranch_scc1 L_fail_b
  s_sleep 32
  s_branch L_poll_b
L_fail_b:
  v_mov_b32 v28, 136
  v_mov_b32 v29, 1
  s_mov_b64 exec, 1
  global_atomic_add v28, v29, s[26:27]
  s_mov_b64 exec, -1
L_ok_b:
  v_mov_b32 v14, v32
  v_mov_b32 v15, v34
  s_nop 1
  v_add_f32_dpp v14, v14, v14 row_ror:4 row_mask:0xf bank_mask:0xf
  v_add_f32_dpp v15, v15, v15 row_ror:4 row_mask:0xf bank_mask:0xf
  s_nop 1
  v_add_f32_dpp v14, v14, v14 row_ror:8 row_mask:0xf bank_mask:0xf
  v_add_f32_dpp v15, v15, v15 row_ror:8 row_mask:0xf bank_mask:0xf
  s_nop 1
  v_mov_b32 v20, v14
  v_mov_b32 v21, v15
  s_nop 1
  v_permlane16_swap_b32 v14, v20
  v_permlane16_swap_b32 v15, v21
  s_nop 1
  v_add_f32 v14, v14, v20
  v_add_f32 v15, v15, v21
  s_nop 1
  v_mov_b32 v20, v14
  v_mov_b32 v21, v15
  s_nop 1
  v_permlane32_swap_b32 v14, v20
  v_permlane32_swap_b32 v15, v21
  s_nop 1
  v_add_f32 v14, v14, v20
  v_add_f32 v15, v15, v21
  v_cvt_pk_bf16_f32 v28, v14, v15
  v_lshlrev_b32 v14, 16, v28
  v_and_b32 v15, s55, v28
  v_mul_f32 v14, v14, v13
  v_mul_f32 v15, v15, v13
  v_cvt_pk_bf16_f32 v28, v14, v15
  v_lshlrev_b32 v14, 16, v28
  v_and_b32 v15, s55, v28
L_nob:
  s_mov_b32 s48, s12
  s_mov_b32 s49, s13
  s_mov_b32 s50, 3670016
  s_mov_b32 s51, 0x00020000
  s_mul_i32 s58, s71, 14336
  v_lshlrev_b32 v6, 2, v0
  s_add_u32 s63, s58, 0
  buffer_load_dword v32, v6, s[48:51], s63 offen offset:0 nt
  buffer_load_dword v33, v6, s[48:51], s63 offen offset:256 nt
  buffer_load_dword v34, v6, s[48:51], s63 offen offset:512 nt
  buffer_load_dword v35, v6, s[48:51], s63 offen offset:768 nt
  buffer_load_dword v36, v6, s[48:51], s63 offen offset:896 nt
  buffer_load_dword v37, v6, s[48:51], s63 offen offset:1152 nt
  buffer_load_dword v38, v6, s[48:51], s63 offen offset:1408 nt
  buffer_load_dword v39, v6, s[48:51], s63 offen offset:1664 nt
  buffer_load_dword v40, v6, s[48:51], s63 offen offset:1792 nt
  buffer_load_dword v41, v6, s[48:51], s63 offen offset:2048 nt
  buffer_load_dword v42, v6, s[48:51], s63 offen offset:2304 nt
  buffer_load_dword v43, v6, s[48:51], s63 offen offset:2560 nt
  buffer_load_dword v44, v6, s[48:51], s63 offen offset:2688 nt
  buffer_load_dword v45, v6, s[48:51], s63 offen offset:2944 nt
  buffer_load_dword v46, v6, s[48:51], s63 offen offset:3200 nt
  buffer_load_dword v47, v6, s[48:51], s63 offen offset:3456 nt
  s_add_u32 s63, s58, 3584
  buffer_load_dword v48, v6, s[48:51], s63 offen offset:0 nt
  buffer_load_dword v49, v6, s[48:51], s63 offen offset:256 nt
  buffer_load_dword v50, v6, s[48:51], s63 offen offset:512 nt
  buffer_load_dword v51, v6, s[48:51], s63 offen offset:768 nt
  buffer_load_dword v52, v6, s[48:51], s63 offen offset:896 nt
  buffer_load_dword v53, v6, s[48:51], s63 offen offset:1152 nt
  buffer_load_dword v54, v6, s[48:51], s63 offen offset:1408 nt
  buffer_load_dword v55, v6, s[48:51], s63 offen offset:1664 nt
  buffer_load_dword v56, v6, s[48:51], s63 offen offset:1792 nt
  buffer_load_dword v57, v6, s[48:51], s63 offen offset:2048 nt
  buffer_load_dword v58, v6, s[48:51], s63 offen offset:2304 nt
  buffer_load_dword v59, v6, s[48:51], s63 offen offset:2560 nt
  buffer_load_dword v60, v6, s[48:51], s63 offen offset:2688 nt
  buffer_load_dword v61, v6, s[48:51], s63 offen offset:2944 nt
  buffer_load_dword v62, v6, s[48:51], s63 offen offset:3200 nt
  buffer_load_dword v63, v6, s[48:51], s63 offen offset:3456 nt
  s_add_u32 s63, s58, 7168
  buffer_load_dword v64, v6, s[48:51], s63 offen offset:0 nt
  buffer_load_dword v65, v6, s[48:51], s63 offen offset:256 nt
  buffer_load_dword v66, v6, s[48:51], s63 offen offset:512 nt
  buffer_load_dword v67, v6, s[48:51], s63 offen offset:768 nt
  buffer_load_dword v68, v6, s[48:51], s63 offen offset:896 nt
  buffer_load_dword v69, v6, s[48:51], s63 offen offset:1152 nt
  buffer_load_dword v70, v6, s[48:51], s63 offen offset:1408 nt
  buffer_load_dword v71, v6, s[48:51], s63 offen offset:1664 nt
  buffer_load_dword v72, v6, s[48:51], s63 offen offset:1792 nt
  buffer_load_dword v73, v6, s[48:51], s63 offen offset:2048 nt
  buffer_load_dword v74, v6, s[48:51], s63 offen offset:2304 nt
  buffer_load_dword v75, v6, s[48:51], s63 offen offset:2560 nt
  buffer_load_dword v76, v6, s[48:51], s63 offen offset:2688 nt
  buffer_load_dword v77, v6, s[48:51], s63 offen offset:2944 nt
  buffer_load_dword v78, v6, s[48:51], s63 offen offset:3200 nt
  buffer_load_dword v79, v6, s[48:51], s63 offen offset:3456 nt
  s_add_u32 s63, s58, 10752
  buffer_load_dword v80, v6, s[48:51], s63 offen offset:0 nt
  buffer_load_dword v81, v6, s[48:51], s63 offen offset:256 nt
  buffer_load_dword v82, v6, s[48:51], s63 offen offset:512 nt
  buffer_load_dword v83, v6, s[48:51], s63 offen offset:768 nt
  buffer_load_dword v84, v6, s[48:51], s63 offen offset:896 nt
  buffer_load_dword v85, v6, s[48:51], s63 offen offset:1152 nt
  buffer_load_dword v86, v6, s[48:51], s63 offen offset:1408 nt
  buffer_load_dword v87, v6, s[48:51], s63 offen offset:1664 nt
  buffer_load_dword v88, v6, s[48:51], s63 offen offset:1792 nt
  buffer_load_dword v89, v6, s[48:51], s63 offen offset:2048 nt
  buffer_load_dword v90, v6, s[48:51], s63 offen offset:2304 nt
  buffer_load_dword v91, v6, s[48:51], s63 offen offset:2560 nt
  buffer_load_dword v92, v6, s[48:51], s63 offen offset:2688 nt
  buffer_load_dword v93, v6, s[48:51], s63 offen offset:2944 nt
  buffer_load_dword v94, v6, s[48:51], s63 offen offset:3200 nt
  buffer_load_dword v95, v6, s[48:51], s63 offen offset:3456 nt
  s_waitcnt vmcnt(0)
  v_perm_b32 v96, v36, v32, s53
  v_perm_b32 v97, v36, v32, s54
  v_perm_b32 v98, v37, v33, s53
  v_perm_b32 v99, v37, v33, s54
  v_perm_b32 v100, v38, v34, s53
  v_perm_b32 v101, v38, v34, s54
  v_perm_b32 v102, v39, v35, s53
  v_perm_b32 v103, v39, v35, s54
  v_perm_b32 v104, v44, v40, s53
  v_perm_b32 v105, v44, v40, s54
  v_perm_b32 v106, v45, v41, s53
  v_perm_b32 v107, v45, v41, s54
  v_perm_b32 v108, v46, v42, s53
  v_perm_b32 v109, v46, v42, s54
  v_perm_b32 v110, v47, v43, s53
  v_perm_b32 v111, v47, v43, s54
  v_perm_b32 v112, v52, v48, s53
  v_perm_b32 v113, v52, v48, s54
  v_perm_b32 v114, v53, v49, s53
  v_perm_b32 v115, v53, v49, s54
  v_perm_b32 v116, v54, v50, s53
  v_perm_b32 v117, v54, v50, s54
  v_perm_b32 v118, v55, v51, s53
  v_perm_b32 v119, v55, v51, s54
  v_perm_b32 v120, v60, v56, s53
  v_perm_b32 v121, v60, v56, s54
  v_perm_b32 v122, v61, v57, s53
  v_perm_b32 v123, v61, v57, s54
  v_perm_b32 v124, v62, v58, s53
  v_perm_b32 v125, v62, v58, s54
  v_perm_b32 v126, v63, v59, s53
  v_perm_b32 v127, v63, v59, s54
  v_perm_b32 v128, v68, v64, s53
  v_perm_b32 v129, v68, v64, s54
  v_perm_b32 v130, v69, v65, s53
  v_perm_b32 v131, v69, v65, s54
  v_perm_b32 v132, v70, v66, s53
  v_perm_b32 v133, v70, v66, s54
  v_perm_b32 v134, v71, v67, s53
  v_perm_b32 v135, v71, v67, s54
  v_perm_b32 v136, v76, v72, s53
  v_perm_b32 v137, v76, v72, s54
  v_perm_b32 v138, v77, v73, s53
  v_perm_b32 v139, v77, v73, s54
  v_perm_b32 v140, v78, v74, s53
  v_perm_b32 v141, v78, v74, s54
  v_perm_b32 v142, v79, v75, s53
  v_perm_b32 v143, v79, v75, s54
  v_perm_b32 v144, v84, v80, s53
  v_perm_b32 v145, v84, v80, s54
  v_perm_b32 v146, v85, v81, s53
  v_perm_b32 v147, v85, v81, s54
  v_perm_b32 v148, v86, v82, s53
  v_perm_b32 v149, v86, v82, s54
  v_perm_b32 v150, v87, v83, s53
  v_perm_b32 v151, v87, v83, s54
  v_perm_b32 v152, v92, v88, s53
  v_perm_b32 v153, v92, v88, s54
  v_perm_b32 v154, v93, v89, s53
  v_perm_b32 v155, v93, v89, s54
  v_perm_b32 v156, v94, v90, s53
  v_perm_b32 v157, v94, v90, s54
  v_perm_b32 v158, v95, v91, s53
  v_perm_b32 v159, v95, v91, s54
  s_mov_b32 s48, s24
  s_mov_b32 s49, s25
  s_mov_b32 s50, 896
  s_mov_b32 s51, 0x00020000
  s_mov_b32 s94, 0
  s_mov_b64 s[96:97], -1
  s_barrier
L_tail:
  s_mov_b32 s63, 4224
  v_mul_lo_u32 v8, v3, s63
  v_lshl_add_u32 v9, v2, 6, v8
  s_mul_i32 s58, s30, 135168
  s_add_u32 s58, s58, 65536
  s_lshl_b32 s57, s31, 7
  s_add_u32 s57, s57, s58
  s_lshr_b32 s56, s31, 4
  s_lshl_b32 s56, s56, 4
  s_add_u32 s56, s56, s58
  s_add_u32 s56, s56, 4096
  s_mov_b64 s[76:77], s[96:97]
  s_mov_b32 s70, 65536
L_poll_p:
  s_mov_b64 exec, s[76:77]
  s_cbranch_execz L_sk_p_0
  buffer_load_dwordx4 v[64:67], v9, s[40:43], s57 offen offset:0 sc1
  buffer_load_dwordx4 v[68:71], v9, s[40:43], s57 offen offset:16 sc1
  buffer_load_dwordx4 v[72:75], v9, s[40:43], s57 offen offset:32 sc1
  buffer_load_dwordx4 v[76:79], v9, s[40:43], s57 offen offset:48 sc1
  buffer_load_dwordx4 v[80:83], v8, s[40:43], s56 offen sc1
L_sk_p_0:
  s_mov_b64 exec, -1
  s_cmp_lg_u32 s94, 0
  s_cbranch_scc1 L_dskip_11
  s_waitcnt vmcnt(0)
L_dskip_11:
  s_mov_b64 s[66:67], 0
  v_max3_u32 v20, v65, v67, v69
  v_max3_u32 v20, v20, v71, v73
  v_max3_u32 v20, v20, v75, v77
  v_max3_u32 v20, v20, v79, v81
  v_max_u32 v20, v20, v83
  v_min3_u32 v21, v65, v67, v69
  v_min3_u32 v21, v21, v71, v73
  v_min3_u32 v21, v21, v75, v77
  v_min3_u32 v21, v21, v79, v81
  v_min_u32 v21, v21, v83
  v_xor_b32 v20, s62, v20
  v_xor_b32 v21, s62, v21
  v_or_b32 v20, v20, v21
  v_cmp_ne_u32 vcc, 0, v20
  s_and_b64 s[76:77], s[76:77], vcc
  s_mov_b64 s[66:67], s[76:77]
  s_cmp_eq_u64 s[66:67], 0
  s_cbranch_scc1 L_ok_p
  s_sub_u32 s70, s70, 1
  s_cmp_eq_u32 s70, 0
  s_cbranch_scc1 L_fail_p
  s_branch L_poll_p
L_fail_p:
  v_mov_b32 v28, 140
  v_mov_b32 v29, 1
  s_mov_b64 exec, 1
  global_atomic_add v28, v29, s[26:27]
  s_mov_b64 exec, -1
L_ok_p:
  v_mov_b32 v24, v80
  s_nop 1
  v_max_f32_dpp v24, v24, v24 row_ror:2 row_mask:0xf bank_mask:0xf
  s_nop 1
  v_max_f32_dpp v24, v24, v24 row_ror:4 row_mask:0xf bank_mask:0xf
  s_nop 1
  v_max_f32_dpp v24, v24, v24 row_ror:8 row_mask:0xf bank_mask:0xf
  s_nop 1
  v_mov_b32 v48, v24
  s_nop 1
  v_permlane16_swap_b32 v24, v48
  s_nop 1
  v_max_f32 v24, v24, v48
  s_nop 1
  v_mov_b32 v48, v24
  s_nop 1
  v_permlane32_swap_b32 v24, v48
  s_nop 1
  v_max_f32 v24, v24, v48
  v_sub_f32 v25, v80, v24
  v_mul_f32 v25, s52, v25
  v_exp_f32 v25, v25
  s_nop 0
  v_mul_f32 v16, v64, v25
  v_mul_f32 v17, v66, v25
  v_mul_f32 v18, v68, v25
  v_mul_f32 v19, v70, v25
  v_mul_f32 v20, v72, v25
  v_mul_f32 v21, v74, v25
  v_mul_f32 v22, v76, v25
  v_mul_f32 v23, v78, v25
  v_mul_f32 v24, v82, v25
  v_add_f32_dpp v16, v16, v16 row_ror:2 row_mask:0xf bank_mask:0xf
  v_add_f32_dpp v17, v17, v17 row_ror:2 row_mask:0xf bank_mask:0xf
  v_add_f32_dpp v18, v18, v18 row_ror:2 row_mask:0xf bank_mask:0xf
  v_add_f32_dpp v19, v19, v19 row_ror:2 row_mask:0xf bank_mask:0xf
  v_add_f32_dpp v20, v20, v20 row_ror:2 row_mask:0xf bank_mask:0xf
  v_add_f32_dpp v21, v21, v21 row_ror:2 row_mask:0xf bank_mask:0xf
  v_add_f32_dpp v22, v22, v22 row_ror:2 row_mask:0xf bank_mask:0xf
  v_add_f32_dpp v23, v23, v23 row_ror:2 row_mask:0xf bank_mask:0xf
  v_add_f32_dpp v24, v24, v24 row_ror:2 row_mask:0xf bank_mask:0xf
  v_add_f32_dpp v16, v16, v16 row_ror:4 row_mask:0xf bank_mask:0xf
  v_add_f32_dpp v17, v17, v17 row_ror:4 row_mask:0xf bank_mask:0xf
  v_add_f32_dpp v18, v18, v18 row_ror:4 row_mask:0xf bank_mask:0xf
  v_add_f32_dpp v19, v19, v19 row_ror:4 row_mask:0xf bank_mask:0xf
  v_add_f32_dpp v20, v20, v20 row_ror:4 row_mask:0xf bank_mask:0xf
  v_add_f32_dpp v21, v21, v21 row_ror:4 row_mask:0xf bank_mask:0xf
  v_add_f32_dpp v22, v22, v22 row_ror:4 row_mask:0xf bank_mask:0xf
  v_add_f32_dpp v23, v23, v23 row_ror:4 row_mask:0xf bank_mask:0xf
  v_add_f32_dpp v24, v24, v24 row_ror:4 row_mask:0xf bank_mask:0xf
  v_add_f32_dpp v16, v16, v16 row_ror:8 row_mask:0xf bank_mask:0xf
  v_add_f32_dpp v17, v17, v17 row_ror:8 row_mask:0xf bank_mask:0xf
  v_add_f32_dpp v18, v18, v18 row_ror:8 row_mask:0xf bank_mask:0xf
  v_add_f32_dpp v19, v19, v19 row_ror:8 row_mask:0xf bank_mask:0xf
  v_add_f32_dpp v20, v20, v20 row_ror:8 row_mask:0xf bank_mask:0xf
  v_add_f32_dpp v21, v21, v21 row_ror:8 row_mask:0xf bank_mask:0xf
  v_add_f32_dpp v22, v22, v22 row_ror:8 row_mask:0xf bank_mask:0xf
  v_add_f32_dpp v23, v23, v23 row_ror:8 row_mask:0xf bank_mask:0xf
  v_add_f32_dpp v24, v24, v24 row_ror:8 row_mask:0xf bank_mask:0xf
  v_mov_b32 v48, v16
  v_mov_b32 v49, v17
  v_mov_b32 v50, v18
  v_mov_b32 v51, v19
  v_mov_b32 v52, v20
  v_mov_b32 v53, v21
  v_mov_b32 v54, v22
  v_mov_b32 v55, v23
  v_mov_b32 v56, v24
  s_nop 1
  v_permlane16_swap_b32 v16, v48
  v_permlane16_swap_b32 v17, v49
  v_permlane16_swap_b32 v18, v50
  v_permlane16_swap_b32 v19, v51
  v_permlane16_swap_b32 v20, v52
  v_permlane16_swap_b32 v21, v53
  v_permlane16_swap_b32 v22, v54
  v_permlane16_swap_b32 v23, v55
  v_permlane16_swap_b32 v24, v56
  s_nop 1
  v_add_f32 v16, v16, v48
  v_add_f32 v17, v17, v49
  v_add_f32 v18, v18, v50
  v_add_f32 v19, v19, v51
  v_add_f32 v20, v20, v52
  v_add_f32 v21, v21, v53
  v_add_f32 v22, v22, v54
  v_add_f32 v23, v23, v55
  v_add_f32 v24, v24, v56
  v_mov_b32 v48, v16
  v_mov_b32 v49, v17
  v_mov_b32 v50, v18
  v_mov_b32 v51, v19
  v_mov_b32 v52, v20
  v_mov_b32 v53, v21
  v_mov_b32 v54, v22
  v_mov_b32 v55, v23
  v_mov_b32 v56, v24
  s_nop 1
  v_permlane32_swap_b32 v16, v48
  v_permlane32_swap_b32 v17, v49
  v_permlane32_swap_b32 v18, v50
  v_permlane32_swap_b32 v19, v51
  v_permlane32_swap_b32 v20, v52
  v_permlane32_swap_b32 v21, v53
  v_permlane32_swap_b32 v22, v54
  v_permlane32_swap_b32 v23, v55
  v_permlane32_swap_b32 v24, v56
  s_nop 1
  v_add_f32 v16, v16, v48
  v_add_f32 v17, v17, v49
  v_add_f32 v18, v18, v50
  v_add_f32 v19, v19, v51
  v_add_f32 v20, v20, v52
  v_add_f32 v21, v21, v53
  v_add_f32 v22, v22, v54
  v_add_f32 v23, v23, v55
  v_add_f32 v24, v24, v56
  v_rcp_f32 v24, v24
  s_nop 0
  v_mul_f32 v16, v16, v24
  v_mul_f32 v17, v17, v24
  v_mul_f32 v18, v18, v24
  v_mul_f32 v19, v19, v24
  v_mul_f32 v20, v20, v24
  v_mul_f32 v21, v21, v24
  v_mul_f32 v22, v22, v24
  v_mul_f32 v23, v23, v24
  v_cvt_pk_bf16_f32 v24, v16, v17
  v_cvt_pk_bf16_f32 v25, v18, v19
  v_cvt_pk_bf16_f32 v26, v20, v21
  v_cvt_pk_bf16_f32 v27, v22, v23
  s_nop 0
  v_readlane_b32 s72, v24, 0
  v_readlane_b32 s73, v25, 0
  v_readlane_b32 s74, v26, 0
  v_readlane_b32 s75, v27, 0
  v_readlane_b32 s76, v24, 1
  v_readlane_b32 s77, v25, 1
  v_readlane_b32 s78, v26, 1
  v_readlane_b32 s79, v27, 1
  s_nop 1
  v_mov_b32 v16, 0
  v_mov_b32 v17, 0
  v_mov_b32 v18, 0
  v_mov_b32 v19, 0
  v_mov_b32 v20, 0
  v_mov_b32 v21, 0
  v_mov_b32 v22, 0
  v_mov_b32 v23, 0
  v_dot2_f32_bf16 v16, v96, s72, v16
  v_dot2_f32_bf16 v17, v97, s72, v17
  v_dot2_f32_bf16 v18, v98, s72, v18
  v_dot2_f32_bf16 v19, v99, s72, v19
  v_dot2_f32_bf16 v20, v100, s72, v20
  v_dot2_f32_bf16 v21, v101, s72, v21
  v_dot2_f32_bf16 v22, v102, s72, v22
  v_dot2_f32_bf16 v23, v103, s72, v23
  v_dot2_f32_bf16 v16, v104, s73, v16
  v_dot2_f32_bf16 v17, v105, s73, v17
  v_dot2_f32_bf16 v18, v106, s73, v18
  v_dot2_f32_bf16 v19, v107, s73, v19
  v_dot2_f32_bf16 v20, v108, s73, v20
  v_dot2_f32_bf16 v21, v109, s73, v21
  v_dot2_f32_bf16 v22, v110, s73, v22
  v_dot2_f32_bf16 v23, v111, s73, v23
  v_dot2_f32_bf16 v16, v112, s74, v16
  v_dot2_f32_bf16 v17, v113, s74, v17
  v_dot2_f32_bf16 v18, v114, s74, v18
  v_dot2_f32_bf16 v19, v115, s74, v19
  v_dot2_f32_bf16 v20, v116, s74, v20
  v_dot2_f32_bf16 v21, v117, s74, v21
  v_dot2_f32_bf16 v22, v118, s74, v22
  v_dot2_f32_bf16 v23, v119, s74, v23
  v_dot2_f32_bf16 v16, v120, s75, v16
  v_dot2_f32_bf16 v17, v121, s75, v17
  v_dot2_f32_bf16 v18, v122, s75, v18
  v_dot2_f32_bf16 v19, v123, s75, v19
  v_dot2_f32_bf16 v20, v124, s75, v20
  v_dot2_f32_bf16 v21, v125, s75, v21
  v_dot2_f32_bf16 v22, v126, s75, v22
  v_dot2_f32_bf16 v23, v127, s75, v23
  v_dot2_f32_bf16 v16, v128, s76, v16
  v_dot2_f32_bf16 v17, v129, s76, v17
  v_dot2_f32_bf16 v18, v130, s76, v18
  v_dot2_f32_bf16 v19, v131, s76, v19
  v_dot2_f32_bf16 v20, v132, s76, v20
  v_dot2_f32_bf16 v21, v133, s76, v21
  v_dot2_f32_bf16 v22, v134, s76, v22
  v_dot2_f32_bf16 v23, v135, s76, v23
  v_dot2_f32_bf16 v16, v136, s77, v16
  v_dot2_f32_bf16 v17, v137, s77, v17
  v_dot2_f32_bf16 v18, v138, s77, v18
  v_dot2_f32_bf16 v19, v139, s77, v19
  v_dot2_f32_bf16 v20, v140, s77, v20
  v_dot2_f32_bf16 v21, v141, s77, v21
  v_dot2_f32_bf16 v22, v142, s77, v22
  v_dot2_f32_bf16 v23, v143, s77, v23
  v_dot2_f32_bf16 v16, v144, s78, v16
  v_dot2_f32_bf16 v17, v145, s78, v17
  v_dot2_f32_bf16 v18, v146, s78, v18
  v_dot2_f32_bf16 v19, v147, s78, v19
  v_dot2_f32_bf16 v20, v148, s78, v20
  v_dot2_f32_bf16 v21, v149, s78, v21
  v_dot2_f32_bf16 v22, v150, s78, v22
  v_dot2_f32_bf16 v23, v151, s78, v23
  v_dot2_f32_bf16 v16, v152, s79, v16
  v_dot2_f32_bf16 v17, v153, s79, v17
  v_dot2_f32_bf16 v18, v154, s79, v18
  v_dot2_f32_bf16 v19, v155, s79, v19
  v_dot2_f32_bf16 v20, v156, s79, v20
  v_dot2_f32_bf16 v21, v157, s79, v21
  v_dot2_f32_bf16 v22, v158, s79, v22
  v_dot2_f32_bf16 v23, v159, s79, v23
  s_lshl_b32 s58, s71, 6
  s_add_u32 s58, s58, 2097152
  v_lshrrev_b32 v28, 2, v0
  v_lshlrev_b32 v28, 14, v28
  v_and_b32 v29, 3, v0
  v_lshl_add_u32 v28, v29, 4, v28
  v_mov_b32 v49, s62
  v_mov_b32 v51, s62
  v_mov_b32 v53, s62
  v_mov_b32 v55, s62
  v_mov_b32 v57, s62
  v_mov_b32 v59, s62
  v_mov_b32 v61, s62
  v_mov_b32 v63, s62
  v_mov_b32 v48, v16
  v_mov_b32 v50, v17
  v_mov_b32 v52, v18
  v_mov_b32 v54, v19
  v_mov_b32 v56, v20
  v_mov_b32 v58, v21
  v_mov_b32 v60, v22
  v_mov_b32 v62, v23
  s_cmp_lg_u32 s94, 0
  s_cbranch_scc1 L_dskip_12
  s_add_u32 s63, s58, 0
  buffer_store_dwordx4 v[48:51], v28, s[40:43], s63 offen sc1
  s_add_u32 s63, s58, 262144
  buffer_store_dwordx4 v[52:55], v28, s[40:43], s63 offen sc1
  s_add_u32 s63, s58, 524288
  buffer_store_dwordx4 v[56:59], v28, s[40:43], s63 offen sc1
  s_add_u32 s63, s58, 786432
  s_mov_b32 exec_hi, 0
  buffer_store_dwordx4 v[60:63], v28, s[40:43], s63 offen sc1
  s_mov_b64 exec, -1
L_dskip_12:
  s_cmp_ge_u32 s71, 56
  s_cbranch_scc1 L_hend
  s_lshl_b32 s58, s71, 14
  s_add_u32 s58, s58, 2097152
  v_lshlrev_b32 v8, 4, v0
  s_add_u32 s84, s58, 0
  s_add_u32 s85, s58, 4096
  s_add_u32 s86, s58, 8192
  s_add_u32 s87, s58, 12288
  s_mov_b64 s[76:77], s[96:97]
  s_mov_b64 s[78:79], s[96:97]
  s_mov_b64 s[80:81], s[96:97]
  s_mov_b64 s[82:83], s[96:97]
  s_mov_b32 s70, 65536
L_poll_a:
  s_mov_b64 exec, s[76:77]
  s_cbranch_execz L_sk_a_0
  buffer_load_dwordx4 v[32:35], v8, s[40:43], s84 offen offset:0 sc1
  buffer_load_dwordx4 v[36:39], v8, s[40:43], s84 offen offset:1024 sc1
  buffer_load_dwordx4 v[40:43], v8, s[40:43], s84 offen offset:2048 sc1
  buffer_load_dwordx4 v[44:47], v8, s[40:43], s84 offen offset:3072 sc1
L_sk_a_0:
  s_mov_b64 exec, s[78:79]
  s_cbranch_execz L_sk_a_1
  buffer_load_dwordx4 v[48:51], v8, s[40:43], s85 offen offset:0 sc1
  buffer_load_dwordx4 v[52:55], v8, s[40:43], s85 offen offset:1024 sc1
  buffer_load_dwordx4 v[56:59], v8, s[40:43], s85 offen offset:2048 sc1
  buffer_load_dwordx4 v[60:63], v8, s[40:43], s85 offen offset:3072 sc1
L_sk_a_1:
  s_mov_b64 exec, s[80:81]
  s_cbranch_execz L_sk_a_2
  buffer_load_dwordx4 v[64:67], v8, s[40:43], s86 offen offset:0 sc1
  buffer_load_dwordx4 v[68:71], v8, s[40:43], s86 offen offset:1024 sc1
  buffer_load_dwordx4 v[72:75], v8, s[40:43], s86 offen offset:2048 sc1
  buffer_load_dwordx4 v[76:79], v8, s[40:43], s86 offen offset:3072 sc1
L_sk_a_2:
  s_mov_b64 exec, s[82:83]
  s_cbranch_execz L_sk_a_3
  buffer_load_dwordx4 v[80:83], v8, s[40:43], s87 offen offset:0 sc1
  buffer_load_dwordx4 v[84:87], v8, s[40:43], s87 offen offset:1024 sc1
  buffer_load_dwordx4 v[88:91], v8, s[40:43], s87 offen offset:2048 sc1
  buffer_load_dwordx4 v[92:95], v8, s[40:43], s87 offen offset:3072 sc1
L_sk_a_3:
  s_mov_b64 exec, -1
  s_cmp_lg_u32 s94, 0
  s_cbranch_scc1 L_dskip_13
  s_waitcnt vmcnt(0)
L_dskip_13:
  s_mov_b64 s[66:67], 0
  v_max3_u32 v20, v33, v35, v37
  v_max3_u32 v20, v20, v39, v41
  v_max3_u32 v20, v20, v43, v45
  v_max_u32 v20, v20, v47
  v_min3_u32 v21, v33, v35, v37
  v_min3_u32 v21, v21, v39, v41
  v_min3_u32 v21, v21, v43, v45
  v_min_u32 v21, v21, v47
  v_max3_u32 v22, v49, v51, v53
  v_max3_u32 v22, v22, v55, v57
  v_max3_u32 v22, v22, v59, v61
  v_max_u32 v22, v22, v63
  v_min3_u32 v23, v49, v51, v53
  v_min3_u32 v23, v23, v55, v57
  v_min3_u32 v23, v23, v59, v61
  v_min_u32 v23, v23, v63
  v_max3_u32 v24, v65, v67, v69
  v_max3_u32 v24, v24, v71, v73
  v_max3_u32 v24, v24, v75, v77
  v_max_u32 v24, v24, v79
  v_min3_u32 v25, v65, v67, v69
  v_min3_u32 v25, v25, v71, v73
  v_min3_u32 v25, v25, v75, v77
  v_min_u32 v25, v25, v79
  v_max3_u32 v26, v81, v83, v85
  v_max3_u32 v26, v26, v87, v89
  v_max3_u32 v26, v26, v91, v93
  v_max_u32 v26, v26, v95
  v_min3_u32 v27, v81, v83, v85
  v_min3_u32 v27, v27, v87, v89
  v_min3_u32 v27, v27, v91, v93
  v_min_u32 v27, v27, v95
  v_xor_b32 v20, s62, v20
  v_xor_b32 v21, s62, v21
  v_xor_b32 v22, s62, v22
  v_xor_b32 v23, s62, v23
  v_xor_b32 v24, s62, v24
  v_xor_b32 v25, s62, v25
  v_xor_b32 v26, s62, v26
  v_xor_b32 v27, s62, v27
  v_or_b32 v20, v20, v21
  v_or_b32 v22, v22, v23
  v_or_b32 v24, v24, v25
  v_or_b32 v26, v26, v27
  v_cmp_ne_u32 vcc, 0, v20
  s_and_b64 s[76:77], s[76:77], vcc
  v_cmp_ne_u32 vcc, 0, v22
  s_and_b64 s[78:79], s[78:79], vcc
  v_cmp_ne_u32 vcc, 0, v24
  s_and_b64 s[80:81], s[80:81], vcc
  v_cmp_ne_u32 vcc, 0, v26
  s_and_b64 s[82:83], s[82:83], vcc
  s_mov_b64 s[66:67], s[76:77]
  s_or_b64 s[66:67], s[66:67], s[78:79]
  s_or_b64 s[66:67], s[66:67], s[80:81]
  s_or_b64 s[66:67], s[66:67], s[82:83]
  s_cmp_eq_u64 s[66:67], 0
  s_cbranch_scc1 L_ok_a
  s_sub_u32 s70, s70, 1
  s_cmp_eq_u32 s70, 0
  s_cbranch_scc1 L_fail_a
  s_branch L_poll_a
L_fail_a:
  v_mov_b32 v28, 144
  v_mov_b32 v29, 1
  s_mov_b64 exec, 1
  global_atomic_add v28, v29, s[26:27]
  s_mov_b64 exec, -1
L_ok_a:
  v_add_f32 v32, v32, v36
  v_add_f32 v34, v34, v38
  v_add_f32 v40, v40, v44
  v_add_f32 v42, v42, v46
  v_add_f32 v48, v48, v52
  v_add_f32 v50, v50, v54
  v_add_f32 v56, v56, v60
  v_add_f32 v58, v58, v62
  v_add_f32 v64, v64, v68
  v_add_f32 v66, v66, v70
  v_add_f32 v72, v72, v76
  v_add_f32 v74, v74, v78
  v_add_f32 v80, v80, v84
  v_add_f32 v82, v82, v86
  v_add_f32 v88, v88, v92
  v_add_f32 v90, v90, v94
  v_add_f32 v32, v32, v40
  v_add_f32 v34, v34, v42
  v_add_f32 v48, v48, v56
  v_add_f32 v50, v50, v58
  v_add_f32 v64, v64, v72
  v_add_f32 v66, v66, v74
  v_add_f32 v80, v80, v88
  v_add_f32 v82, v82, v90
  v_add_f32 v32, v32, v48
  v_add_f32 v34, v34, v50
  v_add_f32 v64, v64, v80
  v_add_f32 v66, v66, v82
  v_add_f32 v16, v32, v64
  v_add_f32 v17, v34, v66
  s_nop 1
  v_add_f32_dpp v16, v16, v16 row_ror:4 row_mask:0xf bank_mask:0xf
  v_add_f32_dpp v17, v17, v17 row_ror:4 row_mask:0xf bank_mask:0xf
  s_nop 1
  v_add_f32_dpp v16, v16, v16 row_ror:8 row_mask:0xf bank_mask:0xf
  v_add_f32_dpp v17, v17, v17 row_ror:8 row_mask:0xf bank_mask:0xf
  s_nop 1
  v_mov_b32 v20, v16
  v_mov_b32 v21, v17
  s_nop 1
  v_permlane16_swap_b32 v16, v20
  v_permlane16_swap_b32 v17, v21
  s_nop 1
  v_add_f32 v16, v16, v20
  v_add_f32 v17, v17, v21
  s_nop 1
  v_mov_b32 v20, v16
  v_mov_b32 v21, v17
  s_nop 1
  v_permlane32_swap_b32 v16, v20
  v_permlane32_swap_b32 v17, v21
  s_nop 1
  v_add_f32 v16, v16, v20
  v_add_f32 v17, v17, v21
  v_cvt_pk_bf16_f32 v28, v16, v17
  v_lshlrev_b32 v16, 16, v28
  v_and_b32 v17, s55, v28
  v_mul_f32 v16, v16, v12
  v_mul_f32 v17, v17, v12
  v_cvt_pk_bf16_f32 v28, v16, v17
  v_lshlrev_b32 v16, 16, v28
  v_and_b32 v17, s55, v28
  v_add_f32 v16, v16, v14
  v_add_f32 v17, v17, v15
  v_cvt_pk_bf16_f32 v16, v16, v17
  s_lshl_b32 s58, s71, 4
  v_lshlrev_b32 v4, 2, v0
  s_cmp_lg_u32 s94, 0
  s_cbranch_scc1 L_hend
  s_mov_b64 exec, 15
  buffer_store_dword v16, v4, s[48:51], s58 offen
  s_cmp_lg_u32 s71, 0
  s_cbranch_scc1 L_hend
  v_mov_b32 v5, s62
  s_mov_b64 exec, 1
  buffer_store_dword v5, v4, s[40:43], 0 offen sc1
L_hend:
  s_mov_b64 exec, -1
  s_endpgm
L_stream:
  s_sub_u32 s3, s3, 1
  s_lshl_b32 s44, s30, 25
  s_add_u32 s32, s6, s44
  s_addc_u32 s33, s7, 0
  s_mov_b32 s34, 0x2000000
  s_mov_b32 s35, 0x00020000
  s_add_u32 s36, s8, s44
  s_addc_u32 s37, s9, 0
  s_mov_b32 s38, 0x2000000
  s_mov_b32 s39, 0x00020000
  v_and_b32 v28, 15, v0
  v_lshrrev_b32 v29, 4, v0
  v_lshlrev_b32 v1, 9, v28
  v_lshl_add_u32 v1, v29, 4, v1
  v_lshlrev_b32 v2, 11, v29
  v_lshl_add_u32 v2, v28, 4, v2
  s_lshl_b32 s49, s30, 1
  s_add_u32 s49, s49, 1
  s_lshl_b32 s49, s49, 7
  s_mul_i32 s45, s30, 22
  s_sub_u32 s58, s45, 60
  s_cmp_ge_u32 s45, 60
  s_cselect_b32 s45, s58, s45
  s_sub_u32 s58, s45, 60
  s_cmp_ge_u32 s45, 60
  s_cselect_b32 s45, s58, s45
  s_sub_u32 s58, s45, 60
  s_cmp_ge_u32 s45, 60
  s_cselect_b32 s45, s58, s45
  s_sub_u32 s58, s45, 60
  s_cmp_ge_u32 s45, 60
  s_cselect_b32 s45, s58, s45
  s_sub_u32 s58, s45, 60
  s_cmp_ge_u32 s45, 60
  s_cselect_b32 s45, s58, s45
  s_sub_u32 s58, s45, 60
  s_cmp_ge_u32 s45, 60
  s_cselect_b32 s45, s58, s45
  s_sub_u32 s58, s45, 60
  s_cmp_ge_u32 s45, 60
  s_cselect_b32 s45, s58, s45
  s_mov_b32 s48, s3
  s_add_u32 s57, s45, s48
  s_sub_u32 s58, s57, 60
  s_cmp_ge_u32 s57, 60
  s_cselect_b32 s57, s58, s57
  s_and_b32 s60, s57, 1
  s_lshr_b32 s57, s57, 1
  s_lshl_b32 s57, s57, 5
  s_and_b32 s59, s31, 7
  s_lshl_b32 s59, s59, 2
  s_lshr_b32 s58, s31, 3
  s_add_u32 s59, s59, s58
  s_add_u32 s59, s57, s59
  s_lshl_b32 s59, s59, 1
  s_add_u32 s59, s59, s60
  s_add_u32 s57, s59, 128
  s_cmp_ge_u32 s59, s49
  s_cselect_b32 s57, s57, s59
  s_lshl_b32 s50, s57, 14
  s_add_u32 s51, s50, 8192
  s_barrier
  buffer_load_dwordx4 a[0:3], v1, s[32:35], s50 offen offset:0 nt
  buffer_load_dwordx4 a[4:7], v1, s[32:35], s50 offen offset:64 nt
  buffer_load_dwordx4 a[8:11], v1, s[32:35], s50 offen offset:128 nt
  buffer_load_dwordx4 a[12:15], v1, s[32:35], s50 offen offset:192 nt
  buffer_load_dwordx4 a[16:19], v1, s[32:35], s50 offen offset:256 nt
  buffer_load_dwordx4 a[20:23], v1, s[32:35], s50 offen offset:320 nt
  buffer_load_dwordx4 a[24:27], v1, s[32:35], s50 offen offset:384 nt
  buffer_load_dwordx4 a[28:31], v1, s[32:35], s50 offen offset:448 nt
  buffer_load_dwordx4 a[32:35], v1, s[32:35], s51 offen offset:0 nt
  buffer_load_dwordx4 a[36:39], v1, s[32:35], s51 offen offset:64 nt
  buffer_load_dwordx4 a[40:43], v1, s[32:35], s51 offen offset:128 nt
  buffer_load_dwordx4 a[44:47], v1, s[32:35], s51 offen offset:192 nt
  buffer_load_dwordx4 a[48:51], v1, s[32:35], s51 offen offset:256 nt
  buffer_load_dwordx4 a[52:55], v1, s[32:35], s51 offen offset:320 nt
  buffer_load_dwordx4 a[56:59], v1, s[32:35], s51 offen offset:384 nt
  buffer_load_dwordx4 a[60:63], v1, s[32:35], s51 offen offset:448 nt
  buffer_load_dwordx4 v[32:35], v2, s[36:39], s50 offen offset:0 nt
  buffer_load_dwordx4 v[36:39], v2, s[36:39], s50 offen offset:512 nt
  buffer_load_dwordx4 v[40:43], v2, s[36:39], s50 offen offset:1024 nt
  buffer_load_dwordx4 v[44:47], v2, s[36:39], s50 offen offset:1536 nt
  buffer_load_dwordx4 v[48:51], v2, s[36:39], s51 offen offset:0 nt
  buffer_load_dwordx4 v[52:55], v2, s[36:39], s51 offen offset:512 nt
  buffer_load_dwordx4 v[56:59], v2, s[36:39], s51 offen offset:1024 nt
  buffer_load_dwordx4 v[60:63], v2, s[36:39], s51 offen offset:1536 nt
  buffer_load_dwordx4 v[64:67], v2, s[36:39], s50 offen offset:256 nt
  buffer_load_dwordx4 v[68:71], v2, s[36:39], s50 offen offset:768 nt
  buffer_load_dwordx4 v[72:75], v2, s[36:39], s50 offen offset:1280 nt
  buffer_load_dwordx4 v[76:79], v2, s[36:39], s50 offen offset:1792 nt
  buffer_load_dwordx4 v[80:83], v2, s[36:39], s51 offen offset:256 nt
  buffer_load_dwordx4 v[84:87], v2, s[36:39], s51 offen offset:768 nt
  buffer_load_dwordx4 v[88:91], v2, s[36:39], s51 offen offset:1280 nt
  buffer_load_dwordx4 v[92:95], v2, s[36:39], s51 offen offset:1792 nt
  s_add_u32 s48, s3, 7
  s_mov_b32 s46, 53
  s_mov_b32 s47, 0
  s_mov_b32 s52, 0x3db8aa3b
  s_mov_b32 s53, 0x05040100
  s_mov_b32 s54, 0x07060302
  s_mov_b32 s55, 0xffff0000
  v_mov_b32 v3, 0xff800000
  v_mov_b32 v4, 0
  v_mov_b32 v5, 0
  s_lshl_b32 s57, s30, 12
  s_add_u32 s57, s57, 3670016
  v_mov_b32 v7, s57
  v_mov_b32 v6, 0
  v_mov_b32 v30, 1
  v_mov_b32 v96, 0
  v_mov_b32 v97, 0
  v_mov_b32 v98, 0
  v_mov_b32 v99, 0
  v_mov_b32 v100, 0
  v_mov_b32 v101, 0
  v_mov_b32 v102, 0
  v_mov_b32 v103, 0
  v_mov_b32 v104, 0
  v_mov_b32 v105, 0
  v_mov_b32 v106, 0
  v_mov_b32 v107, 0
  v_mov_b32 v108, 0
  v_mov_b32 v109, 0
  v_mov_b32 v110, 0
  v_mov_b32 v111, 0
  v_mov_b32 v112, 0
  v_mov_b32 v113, 0
  v_mov_b32 v114, 0
  v_mov_b32 v115, 0
  v_mov_b32 v116, 0
  v_mov_b32 v117, 0
  v_mov_b32 v118, 0
  v_mov_b32 v119, 0
  v_mov_b32 v120, 0
  v_mov_b32 v121, 0
  v_mov_b32 v122, 0
  v_mov_b32 v123, 0
  v_mov_b32 v124, 0
  v_mov_b32 v125, 0
  v_mov_b32 v126, 0
  v_mov_b32 v127, 0
  v_mov_b32 v128, 0
  v_mov_b32 v129, 0
  v_mov_b32 v130, 0
  v_mov_b32 v131, 0
  v_mov_b32 v132, 0
  v_mov_b32 v133, 0
  v_mov_b32 v134, 0
  v_mov_b32 v135, 0
  v_mov_b32 v136, 0
  v_mov_b32 v137, 0
  v_mov_b32 v138, 0
  v_mov_b32 v139, 0
  v_mov_b32 v140, 0
  v_mov_b32 v141, 0
  v_mov_b32 v142, 0
  v_mov_b32 v143, 0
  v_mov_b32 v144, 0
  v_mov_b32 v145, 0
  v_mov_b32 v146, 0
  v_mov_b32 v147, 0
  v_mov_b32 v148, 0
  v_mov_b32 v149, 0
  v_mov_b32 v150, 0
  v_mov_b32 v151, 0
  v_mov_b32 v152, 0
  v_mov_b32 v153, 0
  v_mov_b32 v154, 0
  v_mov_b32 v155, 0
  v_mov_b32 v156, 0
  v_mov_b32 v157, 0
  v_mov_b32 v158, 0
  v_mov_b32 v159, 0
  v_and_b32 v28, 1, v0
  v_lshlrev_b32 v28, 9, v28
  v_lshl_add_u32 v28, v29, 4, v28
  s_barrier
  ds_read_b128 a[64:67], v28 offset:0
  ds_read_b128 a[68:71], v28 offset:64
  ds_read_b128 a[72:75], v28 offset:128
  ds_read_b128 a[76:79], v28 offset:192
  ds_read_b128 a[80:83], v28 offset:256
  ds_read_b128 a[84:87], v28 offset:320
  ds_read_b128 a[88:91], v28 offset:384
  ds_read_b128 a[92:95], v28 offset:448
  s_waitcnt lgkmcnt(0)
L_top:
  s_waitcnt vmcnt(24)
L_top_in:
  s_cmp_ge_u32 s3, 1
  s_cbranch_scc1 L_drain
  s_cmp_eq_u32 s46, 0
  s_cbranch_scc1 L_pool
  s_add_u32 s57, s45, s48
  s_sub_u32 s58, s57, 60
  s_cmp_ge_u32 s57, 60
  s_cselect_b32 s57, s58, s57
  s_and_b32 s60, s57, 1
  s_lshr_b32 s57, s57, 1
  s_lshl_b32 s57, s57, 5
  s_and_b32 s59, s31, 7
  s_lshl_b32 s59, s59, 2
  s_lshr_b32 s58, s31, 3
  s_add_u32 s59, s59, s58
  s_add_u32 s59, s57, s59
  s_lshl_b32 s59, s59, 1
  s_add_u32 s59, s59, s60
  s_add_u32 s57, s59, 128
  s_cmp_ge_u32 s59, s49
  s_cselect_b32 s57, s57, s59
  s_lshl_b32 s50, s57, 14
  s_add_u32 s51, s50, 8192
  s_add_u32 s48, s48, 1
  s_sub_u32 s46, s46, 1
  s_mov_b32 s56, 0
  s_branch L_tkgo
L_pool:
  s_cmp_eq_u32 s47, 0
  s_cbranch_scc1 L_first
  v_readfirstlane_b32 s48, v6
  s_nop 3
  s_add_u32 s48, s48, 32
  s_branch L_chk
L_first:
  s_lshl_b32 s48, s3, 5
  s_add_u32 s48, s48, s31
  s_mov_b32 s47, 1
L_chk:
  s_cmp_ge_u32 s48, 128
  s_cbranch_scc1 L_drain
  s_add_u32 s57, s48, s49
  s_lshl_b32 s50, s57, 14
  s_add_u32 s51, s50, 8192
  s_mov_b32 s56, 1
L_tkgo:
  v_mfma_f32_16x16x32_bf16 v[8:11], a[0:3], a[64:67], 0
  v_mfma_f32_16x16x32_bf16 v[8:11], a[4:7], a[68:71], v[8:11]
  v_mfma_f32_16x16x32_bf16 v[8:11], a[8:11], a[72:75], v[8:11]
  v_mfma_f32_16x16x32_bf16 v[8:11], a[12:15], a[76:79], v[8:11]
  v_mfma_f32_16x16x32_bf16 v[8:11], a[16:19], a[80:83], v[8:11]
  v_mfma_f32_16x16x32_bf16 v[8:11], a[20:23], a[84:87], v[8:11]
  v_mfma_f32_16x16x32_bf16 v[8:11], a[24:27], a[88:91], v[8:11]
  v_mfma_f32_16x16x32_bf16 v[8:11], a[28:31], a[92:95], v[8:11]
  s_cmp_eq_u32 s56, 0
  s_cbranch_scc1 L_noat
  s_mov_b64 exec, 1
  global_atomic_add v6, v7, v30, s[28:29] sc0
  s_mov_b64 exec, -1
L_noat:
  buffer_load_dwordx4 a[0:3], v1, s[32:35], s50 offen offset:0 nt
  buffer_load_dwordx4 a[4:7], v1, s[32:35], s50 offen offset:64 nt
  buffer_load_dwordx4 a[8:11], v1, s[32:35], s50 offen offset:128 nt
  buffer_load_dwordx4 a[12:15], v1, s[32:35], s50 offen offset:192 nt
  buffer_load_dwordx4 a[16:19], v1, s[32:35], s50 offen offset:256 nt
  buffer_load_dwordx4 a[20:23], v1, s[32:35], s50 offen offset:320 nt
  buffer_load_dwordx4 a[24:27], v1, s[32:35], s50 offen offset:384 nt
  buffer_load_dwordx4 a[28:31], v1, s[32:35], s50 offen offset:448 nt
  s_waitcnt vmcnt(24)
  v_mfma_f32_16x16x32_bf16 v[12:15], a[32:35], a[64:67], 0
  v_mfma_f32_16x16x32_bf16 v[12:15], a[36:39], a[68:71], v[12:15]
  v_mfma_f32_16x16x32_bf16 v[12:15], a[40:43], a[72:75], v[12:15]
  v_mfma_f32_16x16x32_bf16 v[12:15], a[44:47], a[76:79], v[12:15]
  v_mfma_f32_16x16x32_bf16 v[12:15], a[48:51], a[80:83], v[12:15]
  v_mfma_f32_16x16x32_bf16 v[12:15], a[52:55], a[84:87], v[12:15]
  v_mfma_f32_16x16x32_bf16 v[12:15], a[56:59], a[88:91], v[12:15]
  v_mfma_f32_16x16x32_bf16 v[12:15], a[60:63], a[92:95], v[12:15]
  buffer_load_dwordx4 a[32:35], v1, s[32:35], s51 offen offset:0 nt
  buffer_load_dwordx4 a[36:39], v1, s[32:35], s51 offen offset:64 nt
  buffer_load_dwordx4 a[40:43], v1, s[32:35], s51 offen offset:128 nt
  buffer_load_dwordx4 a[44:47], v1, s[32:35], s51 offen offset:192 nt
  buffer_load_dwordx4 a[48:51], v1, s[32:35], s51 offen offset:256 nt
  buffer_load_dwordx4 a[52:55], v1, s[32:35], s51 offen offset:320 nt
  buffer_load_dwordx4 a[56:59], v1, s[32:35], s51 offen offset:384 nt
  buffer_load_dwordx4 a[60:63], v1, s[32:35], s51 offen offset:448 nt
  v_cvt_pk_bf16_f32 v16, v8, v9
  v_cvt_pk_bf16_f32 v17, v10, v11
  v_cvt_pk_bf16_f32 v18, v12, v13
  v_cvt_pk_bf16_f32 v19, v14, v15
  v_lshlrev_b32 v8, 16, v16
  v_and_b32 v9, s55, v16
  v_lshlrev_b32 v10, 16, v17
  v_and_b32 v11, s55, v17
  v_lshlrev_b32 v12, 16, v18
  v_and_b32 v13, s55, v18
  v_lshlrev_b32 v14, 16, v19
  v_and_b32 v15, s55, v19
  v_max3_f32 v28, v8, v9, v10
  v_max3_f32 v29, v11, v12, v13
  v_max3_f32 v28, v28, v14, v15
  v_max_f32 v28, v28, v29
  v_cmp_gt_f32 vcc, v28, v3
  s_cbranch_vccnz L_rescale_0
L_back_0:
  v_fma_f32 v8, v8, s52, v5
  v_fma_f32 v9, v9, s52, v5
  v_fma_f32 v10, v10, s52, v5
  v_fma_f32 v11, v11, s52, v5
  v_fma_f32 v12, v12, s52, v5
  v_fma_f32 v13, v13, s52, v5
  v_fma_f32 v14, v14, s52, v5
  v_fma_f32 v15, v15, s52, v5
  v_exp_f32 v8, v8
  v_exp_f32 v9, v9
  v_exp_f32 v10, v10
  v_exp_f32 v11, v11
  v_exp_f32 v12, v12
  v_exp_f32 v13, v13
  v_exp_f32 v14, v14
  v_exp_f32 v15, v15
  v_cvt_pk_bf16_f32 v16, v8, v9
  v_cvt_pk_bf16_f32 v17, v10, v11
  v_cvt_pk_bf16_f32 v18, v12, v13
  v_cvt_pk_bf16_f32 v19, v14, v15
  v_add_f32 v8, v8, v9
  v_add_f32 v10, v10, v11
  v_add_f32 v12, v12, v13
  v_add_f32 v14, v14, v15
  v_add_f32 v8, v8, v10
  v_add_f32 v12, v12, v14
  v_add_f32 v8, v8, v12
  v_add_f32 v4, v4, v8
  s_waitcnt vmcnt(24)
  v_perm_b32 v20, v36, v32, s53
  v_perm_b32 v21, v44, v40, s53
  v_perm_b32 v22, v52, v48, s53
  v_perm_b32 v23, v60, v56, s53
  v_perm_b32 v24, v36, v32, s54
  v_perm_b32 v25, v44, v40, s54
  v_perm_b32 v26, v52, v48, s54
  v_perm_b32 v27, v60, v56, s54
  v_mfma_f32_16x16x32_bf16 v[96:99], v[20:23], v[16:19], v[96:99]
  v_perm_b32 v20, v37, v33, s53
  v_perm_b32 v21, v45, v41, s53
  v_perm_b32 v22, v53, v49, s53
  v_perm_b32 v23, v61, v57, s53
  v_mfma_f32_16x16x32_bf16 v[100:103], v[24:27], v[16:19], v[100:103]
  v_perm_b32 v24, v37, v33, s54
  v_perm_b32 v25, v45, v41, s54
  v_perm_b32 v26, v53, v49, s54
  v_perm_b32 v27, v61, v57, s54
  v_mfma_f32_16x16x32_bf16 v[104:107], v[20:23], v[16:19], v[104:107]
  v_perm_b32 v20, v38, v34, s53
  v_perm_b32 v21, v46, v42, s53
  v_perm_b32 v22, v54, v50, s53
  v_perm_b32 v23, v62, v58, s53
  v_mfma_f32_16x16x32_bf16 v[108:111], v[24:27], v[16:19], v[108:111]
  v_perm_b32 v24, v38, v34, s54
  v_perm_b32 v25, v46, v42, s54
  v_perm_b32 v26, v54, v50, s54
  v_perm_b32 v27, v62, v58, s54
  v_mfma_f32_16x16x32_bf16 v[112:115], v[20:23], v[16:19], v[112:115]
  v_perm_b32 v20, v39, v35, s53
  v_perm_b32 v21, v47, v43, s53
  v_perm_b32 v22, v55, v51, s53
  v_perm_b32 v23, v63, v59, s53
  v_mfma_f32_16x16x32_bf16 v[116:119], v[24:27], v[16:19], v[116:119]
  v_perm_b32 v24, v39, v35, s54
  v_perm_b32 v25, v47, v43, s54
  v_perm_b32 v26, v55, v51, s54
  v_perm_b32 v27, v63, v59, s54
  v_mfma_f32_16x16x32_bf16 v[120:123], v[20:23], v[16:19], v[120:123]
  s_nop 1
  v_mfma_f32_16x16x32_bf16 v[124:127], v[24:27], v[16:19], v[124:127]
  buffer_load_dwordx4 v[32:35], v2, s[36:39], s50 offen offset:0 nt
  buffer_load_dwordx4 v[36:39], v2, s[36:39], s50 offen offset:512 nt
  buffer_load_dwordx4 v[40:43], v2, s[36:39], s50 offen offset:1024 nt
  buffer_load_dwordx4 v[44:47], v2, s[36:39], s50 offen offset:1536 nt
  buffer_load_dwordx4 v[48:51], v2, s[36:39], s51 offen offset:0 nt
  buffer_load_dwordx4 v[52:55], v2, s[36:39], s51 offen offset:512 nt
  buffer_load_dwordx4 v[56:59], v2, s[36:39], s51 offen offset:1024 nt
  buffer_load_dwordx4 v[60:63], v2, s[36:39], s51 offen offset:1536 nt
  s_waitcnt vmcnt(24)
  v_perm_b32 v20, v68, v64, s53
  v_perm_b32 v21, v76, v72, s53
  v_perm_b32 v22, v84, v80, s53
  v_perm_b32 v23, v92, v88, s53
  v_perm_b32 v24, v68, v64, s54
  v_perm_b32 v25, v76, v72, s54
  v_perm_b32 v26, v84, v80, s54
  v_perm_b32 v27, v92, v88, s54
  v_mfma_f32_16x16x32_bf16 v[128:131], v[20:23], v[16:19], v[128:131]
  v_perm_b32 v20, v69, v65, s53
  v_perm_b32 v21, v77, v73, s53
  v_perm_b32 v22, v85, v81, s53
  v_perm_b32 v23, v93, v89, s53
  v_mfma_f32_16x16x32_bf16 v[132:135], v[24:27], v[16:19], v[132:135]
  v_perm_b32 v24, v69, v65, s54
  v_perm_b32 v25, v77, v73, s54
  v_perm_b32 v26, v85, v81, s54
  v_perm_b32 v27, v93, v89, s54
  v_mfma_f32_16x16x32_bf16 v[136:139], v[20:23], v[16:19], v[136:139]
  v_perm_b32 v20, v70, v66, s53
  v_perm_b32 v21, v78, v74, s53
  v_perm_b32 v22, v86, v82, s53
  v_perm_b32 v23, v94, v90, s53
  v_mfma_f32_16x16x32_bf16 v[140:143], v[24:27], v[16:19], v[140:143]
  v_perm_b32 v24, v70, v66, s54
  v_perm_b32 v25, v78, v74, s54
  v_perm_b32 v26, v86, v82, s54
  v_perm_b32 v27, v94, v90, s54
  v_mfma_f32_16x16x32_bf16 v[144:147], v[20:23], v[16:19], v[144:147]
  v_perm_b32 v20, v71, v67, s53
  v_perm_b32 v21, v79, v75, s53
  v_perm_b32 v22, v87, v83, s53
  v_perm_b32 v23, v95, v91, s53
  v_mfma_f32_16x16x32_bf16 v[148:151], v[24:27], v[16:19], v[148:151]
  v_perm_b32 v24, v71, v67, s54
  v_perm_b32 v25, v79, v75, s54
  v_perm_b32 v26, v87, v83, s54
  v_perm_b32 v27, v95, v91, s54
  v_mfma_f32_16x16x32_bf16 v[152:155], v[20:23], v[16:19], v[152:155]
  s_nop 1
  v_mfma_f32_16x16x32_bf16 v[156:159], v[24:27], v[16:19], v[156:159]
  buffer_load_dwordx4 v[64:67], v2, s[36:39], s50 offen offset:256 nt
  buffer_load_dwordx4 v[68:71], v2, s[36:39], s50 offen offset:768 nt
  buffer_load_dwordx4 v[72:75], v2, s[36:39], s50 offen offset:1280 nt
  buffer_load_dwordx4 v[76:79], v2, s[36:39], s50 offen offset:1792 nt
  buffer_load_dwordx4 v[80:83], v2, s[36:39], s51 offen offset:256 nt
  buffer_load_dwordx4 v[84:87], v2, s[36:39], s51 offen offset:768 nt
  buffer_load_dwordx4 v[88:91], v2, s[36:39], s51 offen offset:1280 nt
  buffer_load_dwordx4 v[92:95], v2, s[36:39], s51 offen offset:1792 nt
  s_branch L_top
L_drain:
  v_mfma_f32_16x16x32_bf16 v[8:11], a[0:3], a[64:67], 0
  v_mfma_f32_16x16x32_bf16 v[8:11], a[4:7], a[68:71], v[8:11]
  v_mfma_f32_16x16x32_bf16 v[8:11], a[8:11], a[72:75], v[8:11]
  v_mfma_f32_16x16x32_bf16 v[8:11], a[12:15], a[76:79], v[8:11]
  v_mfma_f32_16x16x32_bf16 v[8:11], a[16:19], a[80:83], v[8:11]
  v_mfma_f32_16x16x32_bf16 v[8:11], a[20:23], a[84:87], v[8:11]
  v_mfma_f32_16x16x32_bf16 v[8:11], a[24:27], a[88:91], v[8:11]
  v_mfma_f32_16x16x32_bf16 v[8:11], a[28:31], a[92:95], v[8:11]
  s_cmp_lg_u32 s3, 0
  s_cbranch_scc1 L_noearly
  v_mov_b32 v6, 0
  s_mov_b32 s70, 65536
L_rdy:
  ds_read_b32 v7, v6 offset:1036
  s_waitcnt lgkmcnt(0)
  v_readfirstlane_b32 s57, v7
  s_sub_u32 s70, s70, 1
  s_cmp_eq_u32 s70, 0
  s_cbranch_scc1 L_rdy_done
  s_cmp_lg_u32 s57, 1
  s_cbranch_scc1 L_rdy
L_rdy_done:
  ds_read_b32 v30, v6 offset:1024
  ds_read_b128 a[8:11], v6 offset:1200
  v_and_b32 v6, 3, v0
  v_lshlrev_b32 v7, 7, v6
  v_bfe_u32 v6, v0, 4, 2
  v_lshl_add_u32 v7, v6, 4, v7
  v_bfe_u32 v6, v0, 2, 2
  v_lshl_add_u32 v7, v6, 2, v7
  ds_read_b32 a0, v7 offset:20480
  ds_read_b32 a1, v7 offset:20544
  ds_read_b32 a2, v7 offset:20992
  ds_read_b32 a3, v7 offset:21056
  ds_read_b32 a4, v7 offset:21504
  ds_read_b32 a5, v7 offset:21568
  ds_read_b32 a6, v7 offset:22016
  ds_read_b32 a7, v7 offset:22080
L_noearly:
  s_waitcnt vmcnt(16)
  v_mfma_f32_16x16x32_bf16 v[12:15], a[32:35], a[64:67], 0
  v_mfma_f32_16x16x32_bf16 v[12:15], a[36:39], a[68:71], v[12:15]
  v_mfma_f32_16x16x32_bf16 v[12:15], a[40:43], a[72:75], v[12:15]
  v_mfma_f32_16x16x32_bf16 v[12:15], a[44:47], a[76:79], v[12:15]
  v_mfma_f32_16x16x32_bf16 v[12:15], a[48:51], a[80:83], v[12:15]
  v_mfma_f32_16x16x32_bf16 v[12:15], a[52:55], a[84:87], v[12:15]
  v_mfma_f32_16x16x32_bf16 v[12:15], a[56:59], a[88:91], v[12:15]
  v_mfma_f32_16x16x32_bf16 v[12:15], a[60:63], a[92:95], v[12:15]
  s_nop 7
  v_cvt_pk_bf16_f32 v16, v8, v9
  v_cvt_pk_bf16_f32 v17, v10, v11
  v_cvt_pk_bf16_f32 v18, v12, v13
  v_cvt_pk_bf16_f32 v19, v14, v15
  v_lshlrev_b32 v8, 16, v16
  v_and_b32 v9, s55, v16
  v_lshlrev_b32 v10, 16, v17
  v_and_b32 v11, s55, v17
  v_lshlrev_b32 v12, 16, v18
  v_and_b32 v13, s55, v18
  v_lshlrev_b32 v14, 16, v19
  v_and_b32 v15, s55, v19
  v_max3_f32 v28, v8, v9, v10
  v_max3_f32 v29, v11, v12, v13
  v_max3_f32 v28, v28, v14, v15
  v_max_f32 v28, v28, v29
  v_cmp_gt_f32 vcc, v28, v3
  s_cbranch_vccnz L_rescale_1
L_back_1:
  v_fma_f32 v8, v8, s52, v5
  v_fma_f32 v9, v9, s52, v5
  v_fma_f32 v10, v10, s52, v5
  v_fma_f32 v11, v11, s52, v5
  v_fma_f32 v12, v12, s52, v5
  v_fma_f32 v13, v13, s52, v5
  v_fma_f32 v14, v14, s52, v5
  v_fma_f32 v15, v15, s52, v5
  v_exp_f32 v8, v8
  v_exp_f32 v9, v9
  v_exp_f32 v10, v10
  v_exp_f32 v11, v11
  v_exp_f32 v12, v12
  v_exp_f32 v13, v13
  v_exp_f32 v14, v14
  v_exp_f32 v15, v15
  v_cvt_pk_bf16_f32 v16, v8, v9
  v_cvt_pk_bf16_f32 v17, v10, v11
  v_cvt_pk_bf16_f32 v18, v12, v13
  v_cvt_pk_bf16_f32 v19, v14, v15
  v_add_f32 v8, v8, v9
  v_add_f32 v10, v10, v11
  v_add_f32 v12, v12, v13
  v_add_f32 v14, v14, v15
  v_add_f32 v8, v8, v10
  v_add_f32 v12, v12, v14
  v_add_f32 v8, v8, v12
  v_add_f32 v4, v4, v8
  v_mov_b32 v28, v4
  s_nop 1
  v_permlane32_swap_b32 v4, v28
  s_nop 1
  v_add_f32 v4, v4, v28
  v_mov_b32 v28, v4
  s_nop 1
  v_permlane16_swap_b32 v4, v28
  s_nop 1
  v_add_f32 v4, v4, v28
  s_cmp_eq_u32 s3, 0
  s_cbranch_scc1 L_w1
  s_waitcnt vmcnt(8)
  v_perm_b32 v20, v36, v32, s53
  v_perm_b32 v21, v44, v40, s53
  v_perm_b32 v22, v52, v48, s53
  v_perm_b32 v23, v60, v56, s53
  v_perm_b32 v24, v36, v32, s54
  v_perm_b32 v25, v44, v40, s54
  v_perm_b32 v26, v52, v48, s54
  v_perm_b32 v27, v60, v56, s54
  v_mfma_f32_16x16x32_bf16 v[96:99], v[20:23], v[16:19], v[96:99]
  v_perm_b32 v20, v37, v33, s53
  v_perm_b32 v21, v45, v41, s53
  v_perm_b32 v22, v53, v49, s53
  v_perm_b32 v23, v61, v57, s53
  v_mfma_f32_16x16x32_bf16 v[100:103], v[24:27], v[16:19], v[100:103]
  v_perm_b32 v24, v37, v33, s54
  v_perm_b32 v25, v45, v41, s54
  v_perm_b32 v26, v53, v49, s54
  v_perm_b32 v27, v61, v57, s54
  v_mfma_f32_16x16x32_bf16 v[104:107], v[20:23], v[16:19], v[104:107]
  v_perm_b32 v20, v38, v34, s53
  v_perm_b32 v21, v46, v42, s53
  v_perm_b32 v22, v54, v50, s53
  v_perm_b32 v23, v62, v58, s53
  v_mfma_f32_16x16x32_bf16 v[108:111], v[24:27], v[16:19], v[108:111]
  v_perm_b32 v24, v38, v34, s54
  v_perm_b32 v25, v46, v42, s54
  v_perm_b32 v26, v54, v50, s54
  v_perm_b32 v27, v62, v58, s54
  v_mfma_f32_16x16x32_bf16 v[112:115], v[20:23], v[16:19], v[112:115]
  v_perm_b32 v20, v39, v35, s53
  v_perm_b32 v21, v47, v43, s53
  v_perm_b32 v22, v55, v51, s53
  v_perm_b32 v23, v63, v59, s53
  v_mfma_f32_16x16x32_bf16 v[116:119], v[24:27], v[16:19], v[116:119]
  v_perm_b32 v24, v39, v35, s54
  v_perm_b32 v25, v47, v43, s54
  v_perm_b32 v26, v55, v51, s54
  v_perm_b32 v27, v63, v59, s54
  v_mfma_f32_16x16x32_bf16 v[120:123], v[20:23], v[16:19], v[120:123]
  s_nop 1
  v_mfma_f32_16x16x32_bf16 v[124:127], v[24:27], v[16:19], v[124:127]
  s_waitcnt vmcnt(0)
  v_perm_b32 v20, v68, v64, s53
  v_perm_b32 v21, v76, v72, s53
  v_perm_b32 v22, v84, v80, s53
  v_perm_b32 v23, v92, v88, s53
  v_perm_b32 v24, v68, v64, s54
  v_perm_b32 v25, v76, v72, s54
  v_perm_b32 v26, v84, v80, s54
  v_perm_b32 v27, v92, v88, s54
  v_mfma_f32_16x16x32_bf16 v[128:131], v[20:23], v[16:19], v[128:131]
  v_perm_b32 v20, v69, v65, s53
  v_perm_b32 v21, v77, v73, s53
  v_perm_b32 v22, v85, v81, s53
  v_perm_b32 v23, v93, v89, s53
  v_mfma_f32_16x16x32_bf16 v[132:135], v[24:27], v[16:19], v[132:135]
  v_perm_b32 v24, v69, v65, s54
  v_perm_b32 v25, v77, v73, s54
  v_perm_b32 v26, v85, v81, s54
  v_perm_b32 v27, v93, v89, s54
  v_mfma_f32_16x16x32_bf16 v[136:139], v[20:23], v[16:19], v[136:139]
  v_perm_b32 v20, v70, v66, s53
  v_perm_b32 v21, v78, v74, s53
  v_perm_b32 v22, v86, v82, s53
  v_perm_b32 v23, v94, v90, s53
  v_mfma_f32_16x16x32_bf16 v[140:143], v[24:27], v[16:19], v[140:143]
  v_perm_b32 v24, v70, v66, s54
  v_perm_b32 v25, v78, v74, s54
  v_perm_b32 v26, v86, v82, s54
  v_perm_b32 v27, v94, v90, s54
  v_mfma_f32_16x16x32_bf16 v[144:147], v[20:23], v[16:19], v[144:147]
  v_perm_b32 v20, v71, v67, s53
  v_perm_b32 v21, v79, v75, s53
  v_perm_b32 v22, v87, v83, s53
  v_perm_b32 v23, v95, v91, s53
  v_mfma_f32_16x16x32_bf16 v[148:151], v[24:27], v[16:19], v[148:151]
  v_perm_b32 v24, v71, v67, s54
  v_perm_b32 v25, v79, v75, s54
  v_perm_b32 v26, v87, v83, s54
  v_perm_b32 v27, v95, v91, s54
  v_mfma_f32_16x16x32_bf16 v[152:155], v[20:23], v[16:19], v[152:155]
  s_nop 1
  v_mfma_f32_16x16x32_bf16 v[156:159], v[24:27], v[16:19], v[156:159]
  s_nop 7
  v_and_b32 v21, 1, v0
  v_lshlrev_b32 v20, 10, v21
  v_lshrrev_b32 v22, 4, v0
  v_lshl_add_u32 v20, v22, 4, v20
  s_lshl_b32 s57, s3, 11
  s_add_u32 s57, s57, 6144
  v_add_u32 v20, s57, v20
  v_mov_b32 v28, v3
  v_mov_b32 v29, v4
  v_lshlrev_b32 v21, 3, v21
  s_lshl_b32 s57, s3, 4
  s_add_u32 s57, s57, 1088
  v_add_u32 v21, s57, v21
  s_mov_b32 s58, 0x00030003
  s_mov_b32 s59, 0x00030003
  s_mov_b64 exec, s[58:59]
  ds_write_b128 v20, v[96:99] offset:0
  ds_write_b128 v20, v[100:103] offset:64
  ds_write_b128 v20, v[104:107] offset:128
  ds_write_b128 v20, v[108:111] offset:192
  ds_write_b128 v20, v[112:115] offset:256
  ds_write_b128 v20, v[116:119] offset:320
  ds_write_b128 v20, v[120:123] offset:384
  ds_write_b128 v20, v[124:127] offset:448
  ds_write_b128 v20, v[128:131] offset:512
  ds_write_b128 v20, v[132:135] offset:576
  ds_write_b128 v20, v[136:139] offset:640
  ds_write_b128 v20, v[140:143] offset:704
  ds_write_b128 v20, v[144:147] offset:768
  ds_write_b128 v20, v[148:151] offset:832
  ds_write_b128 v20, v[152:155] offset:896
  ds_write_b128 v20, v[156:159] offset:960
  s_mov_b64 exec, 3
  ds_write_b64 v21, v[28:29]
  s_mov_b64 exec, -1
  v_mov_b32 v8, 1032
  s_waitcnt lgkmcnt(0)
  s_mov_b64 exec, 1
  ds_add_rtn_u32 v9, v8, v30
  s_mov_b64 exec, -1
  s_waitcnt lgkmcnt(0)
  v_readfirstlane_b32 s57, v9
  s_nop 3
  s_cmp_lg_u32 s57, 5
  s_cbranch_scc1 L_retire
  v_and_b32 v33, 3, v0
  v_lshlrev_b32 v32, 7, v33
  v_bfe_u32 v33, v0, 4, 2
  v_lshl_add_u32 v32, v33, 4, v32
  v_bfe_u32 v33, v0, 2, 2
  v_lshl_add_u32 v32, v33, 2, v32
  v_mov_b32 v33, 0
  ds_read_b64 v[34:35], v33 offset:1104
  ds_read_b64 v[36:37], v33 offset:1120
  ds_read_b64 v[38:39], v33 offset:1136
  ds_read_b64 v[40:41], v33 offset:1152
  ds_read_b64 v[42:43], v33 offset:1168
  ds_read_b64 v[44:45], v33 offset:1184
  ds_read_b64 v[46:47], v33 offset:1112
  ds_read_b64 v[48:49], v33 offset:1128
  ds_read_b64 v[50:51], v33 offset:1144
  ds_read_b64 v[52:53], v33 offset:1160
  ds_read_b64 v[54:55], v33 offset:1176
  ds_read_b64 v[56:57], v33 offset:1192
  s_waitcnt lgkmcnt(0)
  v_max_f32 v58, v34, v36
  v_max_f32 v58, v58, v38
  v_max_f32 v58, v58, v40
  v_max_f32 v58, v58, v42
  v_max_f32 v58, v58, v44
  v_sub_f32 v34, v34, v58
  v_sub_f32 v36, v36, v58
  v_sub_f32 v38, v38, v58
  v_sub_f32 v40, v40, v58
  v_sub_f32 v42, v42, v58
  v_sub_f32 v44, v44, v58
  v_mul_f32 v34, s52, v34
  v_mul_f32 v36, s52, v36
  v_mul_f32 v38, s52, v38
  v_mul_f32 v40, s52, v40
  v_mul_f32 v42, s52, v42
  v_mul_f32 v44, s52, v44
  v_exp_f32 v34, v34
  v_exp_f32 v36, v36
  v_exp_f32 v38, v38
  v_exp_f32 v40, v40
  v_exp_f32 v42, v42
  v_exp_f32 v44, v44
  s_nop 0
  v_mul_f32 v60, v35, v34
  v_fma_f32 v60, v37, v36, v60
  v_fma_f32 v60, v39, v38, v60
  v_fma_f32 v60, v41, v40, v60
  v_fma_f32 v60, v43, v42, v60
  v_fma_f32 v60, v45, v44, v60
  v_max_f32 v59, v46, v48
  v_max_f32 v59, v59, v50
  v_max_f32 v59, v59, v52
  v_max_f32 v59, v59, v54
  v_max_f32 v59, v59, v56
  v_sub_f32 v46, v46, v59
  v_sub_f32 v48, v48, v59
  v_sub_f32 v50, v50, v59
  v_sub_f32 v52, v52, v59
  v_sub_f32 v54, v54, v59
  v_sub_f32 v56, v56, v59
  v_mul_f32 v46, s52, v46
  v_mul_f32 v48, s52, v48
  v_mul_f32 v50, s52, v50
  v_mul_f32 v52, s52, v52
  v_mul_f32 v54, s52, v54
  v_mul_f32 v56, s52, v56
  v_exp_f32 v46, v46
  v_exp_f32 v48, v48
  v_exp_f32 v50, v50
  v_exp_f32 v52, v52
  v_exp_f32 v54, v54
  v_exp_f32 v56, v56
  s_nop 0
  v_mul_f32 v61, v47, v46
  v_fma_f32 v61, v49, v48, v61
  v_fma_f32 v61, v51, v50, v61
  v_fma_f32 v61, v53, v52, v61
  v_fma_f32 v61, v55, v54, v61
  v_fma_f32 v61, v57, v56, v61
  ds_read_b32 v62, v32 offset:8192
  ds_read_b32 v63, v32 offset:8256
  ds_read_b32 v64, v32 offset:10240
  ds_read_b32 v65, v32 offset:10304
  ds_read_b32 v66, v32 offset:12288
  ds_read_b32 v67, v32 offset:12352
  ds_read_b32 v68, v32 offset:14336
  ds_read_b32 v69, v32 offset:14400
  ds_read_b32 v70, v32 offset:16384
  ds_read_b32 v71, v32 offset:16448
  ds_read_b32 v72, v32 offset:18432
  ds_read_b32 v73, v32 offset:18496
  s_waitcnt lgkmcnt(0)
  v_mul_f32 v76, v62, v34
  v_mul_f32 v78, v63, v34
  v_fma_f32 v76, v64, v36, v76
  v_fma_f32 v78, v65, v36, v78
  v_fma_f32 v76, v66, v38, v76
  v_fma_f32 v78, v67, v38, v78
  v_fma_f32 v76, v68, v40, v76
  v_fma_f32 v78, v69, v40, v78
  v_fma_f32 v76, v70, v42, v76
  v_fma_f32 v78, v71, v42, v78
  v_fma_f32 v76, v72, v44, v76
  v_fma_f32 v78, v73, v44, v78
  ds_read_b32 v62, v32 offset:8704
  ds_read_b32 v63, v32 offset:8768
  ds_read_b32 v64, v32 offset:10752
  ds_read_b32 v65, v32 offset:10816
  ds_read_b32 v66, v32 offset:12800
  ds_read_b32 v67, v32 offset:12864
  ds_read_b32 v68, v32 offset:14848
  ds_read_b32 v69, v32 offset:14912
  ds_read_b32 v70, v32 offset:16896
  ds_read_b32 v71, v32 offset:16960
  ds_read_b32 v72, v32 offset:18944
  ds_read_b32 v73, v32 offset:19008
  s_waitcnt lgkmcnt(0)
  v_mul_f32 v80, v62, v34
  v_mul_f32 v82, v63, v34
  v_fma_f32 v80, v64, v36, v80
  v_fma_f32 v82, v65, v36, v82
  v_fma_f32 v80, v66, v38, v80
  v_fma_f32 v82, v67, v38, v82
  v_fma_f32 v80, v68, v40, v80
  v_fma_f32 v82, v69, v40, v82
  v_fma_f32 v80, v70, v42, v80
  v_fma_f32 v82, v71, v42, v82
  v_fma_f32 v80, v72, v44, v80
  v_fma_f32 v82, v73, v44, v82
  ds_read_b32 v62, v32 offset:9216
  ds_read_b32 v63, v32 offset:9280
  ds_read_b32 v64, v32 offset:11264
  ds_read_b32 v65, v32 offset:11328
  ds_read_b32 v66, v32 offset:13312
  ds_read_b32 v67, v32 offset:13376
  ds_read_b32 v68, v32 offset:15360
  ds_read_b32 v69, v32 offset:15424
  ds_read_b32 v70, v32 offset:17408
  ds_read_b32 v71, v32 offset:17472
  ds_read_b32 v72, v32 offset:19456
  ds_read_b32 v73, v32 offset:19520
  s_waitcnt lgkmcnt(0)
  v_mul_f32 v84, v62, v46
  v_mul_f32 v86, v63, v46
  v_fma_f32 v84, v64, v48, v84
  v_fma_f32 v86, v65, v48, v86
  v_fma_f32 v84, v66, v50, v84
  v_fma_f32 v86, v67, v50, v86
  v_fma_f32 v84, v68, v52, v84
  v_fma_f32 v86, v69, v52, v86
  v_fma_f32 v84, v70, v54, v84
  v_fma_f32 v86, v71, v54, v86
  v_fma_f32 v84, v72, v56, v84
  v_fma_f32 v86, v73, v56, v86
  ds_read_b32 v62, v32 offset:9728
  ds_read_b32 v63, v32 offset:9792
  ds_read_b32 v64, v32 offset:11776
  ds_read_b32 v65, v32 offset:11840
  ds_read_b32 v66, v32 offset:13824
  ds_read_b32 v67, v32 offset:13888
  ds_read_b32 v68, v32 offset:15872
  ds_read_b32 v69, v32 offset:15936
  ds_read_b32 v70, v32 offset:17920
  ds_read_b32 v71, v32 offset:17984
  ds_read_b32 v72, v32 offset:19968
  ds_read_b32 v73, v32 offset:20032
  s_waitcnt lgkmcnt(0)
  v_mul_f32 v88, v62, v46
  v_mul_f32 v90, v63, v46
  v_fma_f32 v88, v64, v48, v88
  v_fma_f32 v90, v65, v48, v90
  v_fma_f32 v88, v66, v50, v88
  v_fma_f32 v90, v67, v50, v90
  v_fma_f32 v88, v68, v52, v88
  v_fma_f32 v90, v69, v52, v90
  v_fma_f32 v88, v70, v54, v88
  v_fma_f32 v90, v71, v54, v90
  v_fma_f32 v88, v72, v56, v88
  v_fma_f32 v90, v73, v56, v90
  ds_write_b32 v32, v76 offset:20480
  ds_write_b32 v32, v78 offset:20544
  ds_write_b32 v32, v80 offset:20992
  ds_write_b32 v32, v82 offset:21056
  ds_write_b32 v32, v84 offset:21504
  ds_write_b32 v32, v86 offset:21568
  ds_write_b32 v32, v88 offset:22016
  ds_write_b32 v32, v90 offset:22080
  v_mov_b32 v8, v58
  v_mov_b32 v9, v60
  v_mov_b32 v10, v59
  v_mov_b32 v11, v61
  v_mov_b32 v12, 0
  s_mov_b64 exec, 1
  ds_write_b128 v12, v[8:11] offset:1200
  s_waitcnt lgkmcnt(0)
  ds_write_b32 v12, v30 offset:1036
  s_mov_b64 exec, -1
  s_waitcnt lgkmcnt(0)
L_retire:
  s_endpgm
L_w1:
  s_mov_b32 s94, 0
L_w1_go:
  s_waitcnt lgkmcnt(0)
  v_accvgpr_read_b32 v12, a8
  v_accvgpr_read_b32 v13, a9
  v_accvgpr_read_b32 v14, a10
  v_accvgpr_read_b32 v15, a11
  v_mov_b32 v8, v7
  v_mov_b32_dpp v9, v3 quad_perm:[1,0,3,2] row_mask:0xf bank_mask:0xf
  v_mov_b32_dpp v10, v4 quad_perm:[1,0,3,2] row_mask:0xf bank_mask:0xf
  v_and_b32 v29, 1, v0
  v_cmp_eq_u32 vcc, 1, v29
  s_nop 1
  v_cndmask_b32 v5, v3, v9, vcc
  v_cndmask_b32 v6, v9, v3, vcc
  v_cndmask_b32 v7, v4, v10, vcc
  v_cndmask_b32 v11, v10, v4, vcc
  v_lshlrev_b32 v9, 10, v29
  v_lshrrev_b32 v10, 4, v0
  v_lshl_add_u32 v9, v10, 4, v9
  s_lshl_b32 s57, s30, 5
  s_add_u32 s57, s57, s31
  s_mul_i32 s57, s57, 4224
  s_add_u32 s57, s57, 65536
  s_mov_b32 s58, 0x00030003
  s_mov_b32 s59, 0x00030003
  s_waitcnt lgkmcnt(0)
  v_max_f32 v3, v12, v5
  v_max_f32 v4, v14, v6
  v_sub_f32 v12, v12, v3
  v_sub_f32 v5, v5, v3
  v_sub_f32 v14, v14, v4
  v_sub_f32 v6, v6, v4
  v_mul_f32 v12, s52, v12
  v_mul_f32 v5, s52, v5
  v_mul_f32 v14, s52, v14
  v_mul_f32 v6, s52, v6
  v_exp_f32 v12, v12
  v_exp_f32 v5, v5
  v_exp_f32 v14, v14
  v_exp_f32 v6, v6
  s_nop 0
  v_mul_f32 v13, v13, v12
  v_mul_f32 v15, v15, v14
  v_fma_f32 v13, v7, v5, v13
  v_fma_f32 v15, v11, v6, v15
  s_waitcnt vmcnt(8)
  v_perm_b32 v20, v36, v32, s53
  v_perm_b32 v21, v44, v40, s53
  v_perm_b32 v22, v52, v48, s53
  v_perm_b32 v23, v60, v56, s53
  v_perm_b32 v24, v36, v32, s54
  v_perm_b32 v25, v44, v40, s54
  v_perm_b32 v26, v52, v48, s54
  v_perm_b32 v27, v60, v56, s54
  v_mfma_f32_16x16x32_bf16 v[96:99], v[20:23], v[16:19], v[96:99]
  v_perm_b32 v20, v37, v33, s53
  v_perm_b32 v21, v45, v41, s53
  v_perm_b32 v22, v53, v49, s53
  v_perm_b32 v23, v61, v57, s53
  v_mfma_f32_16x16x32_bf16 v[100:103], v[24:27], v[16:19], v[100:103]
  v_perm_b32 v24, v37, v33, s54
  v_perm_b32 v25, v45, v41, s54
  v_perm_b32 v26, v53, v49, s54
  v_perm_b32 v27, v61, v57, s54
  v_mfma_f32_16x16x32_bf16 v[104:107], v[20:23], v[16:19], v[104:107]
  v_perm_b32 v20, v38, v34, s53
  v_perm_b32 v21, v46, v42, s53
  v_perm_b32 v22, v54, v50, s53
  v_perm_b32 v23, v62, v58, s53
  v_mfma_f32_16x16x32_bf16 v[108:111], v[24:27], v[16:19], v[108:111]
  v_perm_b32 v24, v38, v34, s54
  v_perm_b32 v25, v46, v42, s54
  v_perm_b32 v26, v54, v50, s54
  v_perm_b32 v27, v62, v58, s54
  v_mfma_f32_16x16x32_bf16 v[112:115], v[20:23], v[16:19], v[112:115]
  v_perm_b32 v20, v39, v35, s53
  v_perm_b32 v21, v47, v43, s53
  v_perm_b32 v22, v55, v51, s53
  v_perm_b32 v23, v63, v59, s53
  v_mfma_f32_16x16x32_bf16 v[116:119], v[24:27], v[16:19], v[116:119]
  v_perm_b32 v24, v39, v35, s54
  v_perm_b32 v25, v47, v43, s54
  v_perm_b32 v26, v55, v51, s54
  v_perm_b32 v27, v63, v59, s54
  v_mfma_f32_16x16x32_bf16 v[120:123], v[20:23], v[16:19], v[120:123]
  s_nop 1
  v_mfma_f32_16x16x32_bf16 v[124:127], v[24:27], v[16:19], v[124:127]
  s_waitcnt vmcnt(0)
  v_perm_b32 v20, v68, v64, s53
  v_perm_b32 v21, v76, v72, s53
  v_perm_b32 v22, v84, v80, s53
  v_perm_b32 v23, v92, v88, s53
  v_perm_b32 v24, v68, v64, s54
  v_perm_b32 v25, v76, v72, s54
  v_perm_b32 v26, v84, v80, s54
  v_perm_b32 v27, v92, v88, s54
  v_mfma_f32_16x16x32_bf16 v[128:131], v[20:23], v[16:19], v[128:131]
  v_perm_b32 v20, v69, v65, s53
  v_perm_b32 v21, v77, v73, s53
  v_perm_b32 v22, v85, v81, s53
  v_perm_b32 v23, v93, v89, s53
  v_mfma_f32_16x16x32_bf16 v[132:135], v[24:27], v[16:19], v[132:135]
  v_perm_b32 v24, v69, v65, s54
  v_perm_b32 v25, v77, v73, s54
  v_perm_b32 v26, v85, v81, s54
  v_perm_b32 v27, v93, v89, s54
  v_mfma_f32_16x16x32_bf16 v[136:139], v[20:23], v[16:19], v[136:139]
  v_perm_b32 v20, v70, v66, s53
  v_perm_b32 v21, v78, v74, s53
  v_perm_b32 v22, v86, v82, s53
  v_perm_b32 v23, v94, v90, s53
  v_mfma_f32_16x16x32_bf16 v[140:143], v[24:27], v[16:19], v[140:143]
  v_perm_b32 v24, v70, v66, s54
  v_perm_b32 v25, v78, v74, s54
  v_perm_b32 v26, v86, v82, s54
  v_perm_b32 v27, v94, v90, s54
  v_mfma_f32_16x16x32_bf16 v[144:147], v[20:23], v[16:19], v[144:147]
  v_perm_b32 v20, v71, v67, s53
  v_perm_b32 v21, v79, v75, s53
  v_perm_b32 v22, v87, v83, s53
  v_perm_b32 v23, v95, v91, s53
  v_mfma_f32_16x16x32_bf16 v[148:151], v[24:27], v[16:19], v[148:151]
  v_perm_b32 v24, v71, v67, s54
  v_perm_b32 v25, v79, v75, s54
  v_perm_b32 v26, v87, v83, s54
  v_perm_b32 v27, v95, v91, s54
  v_mfma_f32_16x16x32_bf16 v[152:155], v[20:23], v[16:19], v[152:155]
  s_nop 1
  v_mfma_f32_16x16x32_bf16 v[156:159], v[24:27], v[16:19], v[156:159]
  s_mov_b64 exec, s[58:59]
  ds_write_b128 v9, v[96:99] offset:6144
  ds_write_b128 v9, v[100:103] offset:6208
  ds_write_b128 v9, v[104:107] offset:6272
  ds_write_b128 v9, v[108:111] offset:6336
  ds_write_b128 v9, v[112:115] offset:6400
  ds_write_b128 v9, v[116:119] offset:6464
  ds_write_b128 v9, v[120:123] offset:6528
  ds_write_b128 v9, v[124:127] offset:6592
  s_nop 3
  ds_write_b128 v9, v[128:131] offset:6656
  ds_write_b128 v9, v[132:135] offset:6720
  ds_write_b128 v9, v[136:139] offset:6784
  ds_write_b128 v9, v[140:143] offset:6848
  ds_write_b128 v9, v[144:147] offset:6912
  ds_write_b128 v9, v[148:151] offset:6976
  ds_write_b128 v9, v[152:155] offset:7040
  ds_write_b128 v9, v[156:159] offset:7104
  s_mov_b64 exec, -1
  ds_read_b32 v32, v8 offset:6144
  ds_read_b32 v33, v8 offset:6208
  ds_read_b32 v34, v8 offset:6656
  ds_read_b32 v35, v8 offset:6720
  ds_read_b32 v36, v8 offset:7168
  ds_read_b32 v37, v8 offset:7232
  ds_read_b32 v38, v8 offset:7680
  ds_read_b32 v39, v8 offset:7744
  v_accvgpr_read_b32 v40, a0
  v_accvgpr_read_b32 v41, a1
  v_accvgpr_read_b32 v42, a2
  v_accvgpr_read_b32 v43, a3
  v_accvgpr_read_b32 v44, a4
  v_accvgpr_read_b32 v45, a5
  v_accvgpr_read_b32 v46, a6
  v_accvgpr_read_b32 v47, a7
  v_cmp_eq_u32 vcc, 1, v0
  v_mov_b32 v65, v30
  v_mov_b32 v67, v30
  v_cndmask_b32 v64, v3, v4, vcc
  v_cndmask_b32 v66, v13, v15, vcc
  v_lshlrev_b32 v16, 4, v0
  v_mul_f32 v48, v40, v12
  v_mul_f32 v50, v41, v12
  v_mov_b32 v49, v30
  v_mov_b32 v51, v30
  v_mul_f32 v52, v42, v12
  v_mul_f32 v54, v43, v12
  v_mov_b32 v53, v30
  v_mov_b32 v55, v30
  v_mul_f32 v56, v44, v14
  v_mul_f32 v58, v45, v14
  v_mov_b32 v57, v30
  v_mov_b32 v59, v30
  v_mul_f32 v60, v46, v14
  v_mul_f32 v62, v47, v14
  v_mov_b32 v61, v30
  v_mov_b32 v63, v30
  s_waitcnt lgkmcnt(0)
  v_fma_f32 v48, v32, v5, v48
  v_fma_f32 v50, v33, v5, v50
  v_fma_f32 v52, v34, v5, v52
  v_fma_f32 v54, v35, v5, v54
  v_fma_f32 v56, v36, v6, v56
  v_fma_f32 v58, v37, v6, v58
  v_fma_f32 v60, v38, v6, v60
  v_fma_f32 v62, v39, v6, v62
  s_cmp_lg_u32 s94, 0
  s_cbranch_scc1 L_retire
  buffer_store_dwordx4 v[48:51], v16, s[40:43], s57 offen offset:0 sc1
  buffer_store_dwordx4 v[52:55], v16, s[40:43], s57 offen offset:1024 sc1
  buffer_store_dwordx4 v[56:59], v16, s[40:43], s57 offen offset:2048 sc1
  buffer_store_dwordx4 v[60:63], v16, s[40:43], s57 offen offset:3072 sc1
  s_add_u32 s57, s57, 4096
  s_mov_b64 exec, 3
  buffer_store_dwordx4 v[64:67], v16, s[40:43], s57 offen sc1
  s_mov_b64 exec, -1
  s_barrier
  s_branch L_retire
L_rescale_0:
  v_max_f32 v28, v28, v3
  v_mov_b32 v29, v28
  s_nop 1
  v_permlane32_swap_b32 v28, v29
  s_nop 1
  v_max_f32 v28, v28, v29
  v_mov_b32 v29, v28
  s_nop 1
  v_permlane16_swap_b32 v28, v29
  s_nop 1
  v_max_f32 v28, v28, v29
  v_sub_f32 v29, v3, v28
  v_mul_f32 v29, s52, v29
  v_exp_f32 v29, v29
  v_mov_b32 v3, v28
  v_mul_f32 v5, s52, v28
  v_sub_f32 v5, 0, v5
  v_mul_f32 v4, v4, v29
  v_mul_f32 v96, v96, v29
  v_mul_f32 v97, v97, v29
  v_mul_f32 v98, v98, v29
  v_mul_f32 v99, v99, v29
  v_mul_f32 v100, v100, v29
  v_mul_f32 v101, v101, v29
  v_mul_f32 v102, v102, v29
  v_mul_f32 v103, v103, v29
  v_mul_f32 v104, v104, v29
  v_mul_f32 v105, v105, v29
  v_mul_f32 v106, v106, v29
  v_mul_f32 v107, v107, v29
  v_mul_f32 v108, v108, v29
  v_mul_f32 v109, v109, v29
  v_mul_f32 v110, v110, v29
  v_mul_f32 v111, v111, v29
  v_mul_f32 v112, v112, v29
  v_mul_f32 v113, v113, v29
  v_mul_f32 v114, v114, v29
  v_mul_f32 v115, v115, v29
  v_mul_f32 v116, v116, v29
  v_mul_f32 v117, v117, v29
  v_mul_f32 v118, v118, v29
  v_mul_f32 v119, v119, v29
  v_mul_f32 v120, v120, v29
  v_mul_f32 v121, v121, v29
  v_mul_f32 v122, v122, v29
  v_mul_f32 v123, v123, v29
  v_mul_f32 v124, v124, v29
  v_mul_f32 v125, v125, v29
  v_mul_f32 v126, v126, v29
  v_mul_f32 v127, v127, v29
  v_mul_f32 v128, v128, v29
  v_mul_f32 v129, v129, v29
  v_mul_f32 v130, v130, v29
  v_mul_f32 v131, v131, v29
  v_mul_f32 v132, v132, v29
  v_mul_f32 v133, v133, v29
  v_mul_f32 v134, v134, v29
  v_mul_f32 v135, v135, v29
  v_mul_f32 v136, v136, v29
  v_mul_f32 v137, v137, v29
  v_mul_f32 v138, v138, v29
  v_mul_f32 v139, v139, v29
  v_mul_f32 v140, v140, v29
  v_mul_f32 v141, v141, v29
  v_mul_f32 v142, v142, v29
  v_mul_f32 v143, v143, v29
  v_mul_f32 v144, v144, v29
  v_mul_f32 v145, v145, v29
  v_mul_f32 v146, v146, v29
  v_mul_f32 v147, v147, v29
  v_mul_f32 v148, v148, v29
  v_mul_f32 v149, v149, v29
  v_mul_f32 v150, v150, v29
  v_mul_f32 v151, v151, v29
  v_mul_f32 v152, v152, v29
  v_mul_f32 v153, v153, v29
  v_mul_f32 v154, v154, v29
  v_mul_f32 v155, v155, v29
  v_mul_f32 v156, v156, v29
  v_mul_f32 v157, v157, v29
  v_mul_f32 v158, v158, v29
  v_mul_f32 v159, v159, v29
  s_branch L_back_0
L_rescale_1:
  v_max_f32 v28, v28, v3
  v_mov_b32 v29, v28
  s_nop 1
  v_permlane32_swap_b32 v28, v29
  s_nop 1
  v_max_f32 v28, v28, v29
  v_mov_b32 v29, v28
  s_nop 1
  v_permlane16_swap_b32 v28, v29
  s_nop 1
  v_max_f32 v28, v28, v29
  v_sub_f32 v29, v3, v28
  v_mul_f32 v29, s52, v29
  v_exp_f32 v29, v29
  v_mov_b32 v3, v28
  v_mul_f32 v5, s52, v28
  v_sub_f32 v5, 0, v5
  v_mul_f32 v4, v4, v29
  v_mul_f32 v96, v96, v29
  v_mul_f32 v97, v97, v29
  v_mul_f32 v98, v98, v29
  v_mul_f32 v99, v99, v29
  v_mul_f32 v100, v100, v29
  v_mul_f32 v101, v101, v29
  v_mul_f32 v102, v102, v29
  v_mul_f32 v103, v103, v29
  v_mul_f32 v104, v104, v29
  v_mul_f32 v105, v105, v29
  v_mul_f32 v106, v106, v29
  v_mul_f32 v107, v107, v29
  v_mul_f32 v108, v108, v29
  v_mul_f32 v109, v109, v29
  v_mul_f32 v110, v110, v29
  v_mul_f32 v111, v111, v29
  v_mul_f32 v112, v112, v29
  v_mul_f32 v113, v113, v29
  v_mul_f32 v114, v114, v29
  v_mul_f32 v115, v115, v29
  v_mul_f32 v116, v116, v29
  v_mul_f32 v117, v117, v29
  v_mul_f32 v118, v118, v29
  v_mul_f32 v119, v119, v29
  v_mul_f32 v120, v120, v29
  v_mul_f32 v121, v121, v29
  v_mul_f32 v122, v122, v29
  v_mul_f32 v123, v123, v29
  v_mul_f32 v124, v124, v29
  v_mul_f32 v125, v125, v29
  v_mul_f32 v126, v126, v29
  v_mul_f32 v127, v127, v29
  v_mul_f32 v128, v128, v29
  v_mul_f32 v129, v129, v29
  v_mul_f32 v130, v130, v29
  v_mul_f32 v131, v131, v29
  v_mul_f32 v132, v132, v29
  v_mul_f32 v133, v133, v29
  v_mul_f32 v134, v134, v29
  v_mul_f32 v135, v135, v29
  v_mul_f32 v136, v136, v29
  v_mul_f32 v137, v137, v29
  v_mul_f32 v138, v138, v29
  v_mul_f32 v139, v139, v29
  v_mul_f32 v140, v140, v29
  v_mul_f32 v141, v141, v29
  v_mul_f32 v142, v142, v29
  v_mul_f32 v143, v143, v29
  v_mul_f32 v144, v144, v29
  v_mul_f32 v145, v145, v29
  v_mul_f32 v146, v146, v29
  v_mul_f32 v147, v147, v29
  v_mul_f32 v148, v148, v29
  v_mul_f32 v149, v149, v29
  v_mul_f32 v150, v150, v29
  v_mul_f32 v151, v151, v29
  v_mul_f32 v152, v152, v29
  v_mul_f32 v153, v153, v29
  v_mul_f32 v154, v154, v29
  v_mul_f32 v155, v155, v29
  v_mul_f32 v156, v156, v29
  v_mul_f32 v157, v157, v29
  v_mul_f32 v158, v158, v29
  v_mul_f32 v159, v159, v29
  s_branch L_back_1
L_end:
  s_endpgm
KEND:
.section .rodata,"a"
.p2align 6
.amdhsa_kernel gated_mix__gqa_block_cached__glu_gated_reglu__decode_kernel
  .amdhsa_next_free_vgpr 256
  .amdhsa_next_free_sgpr 100
  .amdhsa_accum_offset 160
  .amdhsa_group_segment_fixed_size 0
  .amdhsa_kernarg_size 104
  .amdhsa_user_sgpr_count 2
  .amdhsa_user_sgpr_kernarg_segment_ptr 1
  .amdhsa_system_sgpr_workgroup_id_x 1
.end_amdhsa_kernel
```
